```python
import torch

def _softmax(x, axis=-1):
    return torch.softmax(x, dim=axis)

def _gelu(x):
    return torch.nn.functional.gelu(x, approximate='tanh')

def _silu(x):
    return torch.nn.functional.silu(x)

def _sigmoid(x):
    return torch.sigmoid(x)

def _layernorm(x, axis=-1, eps=1e-05):
    m = x.mean(dim=axis, keepdim=True)
    v = x.var(dim=axis, keepdim=True, unbiased=False)
    return (x - m) / torch.sqrt(v + eps)

def _scatter_add(tgt, idx, src, axis=0):
    return tgt.clone().index_add_(axis, idx, src)

def _segment_sum(src, seg, n):
    out = torch.zeros((n,) + src.shape[1:], dtype=src.dtype)
    return out.index_add_(0, seg, src)

def _pad(x, pw):
    flat = tuple((v for pair in reversed(pw) for v in pair))
    return torch.nn.functional.pad(x, flat)
kernel_name = 'adaLN_cond__sliding_local_dilated__dense_activation_silu__prompt'

def setup_inputs():

    _w = lambda a: (lambda t: t.to(torch.bfloat16) if t.is_floating_point() else t)(torch.as_tensor(a))

    def _A_setup():
        B, S, D = (1, 2048, 640)
        return {'x': _w((lambda *s: torch.randn(*s, dtype=torch.bfloat16) * 0.05)(B, S, D)), 'wqkv': _w((lambda *s: torch.randn(*s, dtype=torch.bfloat16) * 0.05)(D, 3 * D)), 'wo': _w((lambda *s: torch.randn(*s, dtype=torch.bfloat16) * 0.05)(D, D))}
    _A_in = _A_setup()

    def _B_setup():
        B, S, D, F = (1, 2048, 640, 1536)
        return {'x': _w((lambda *s: torch.randn(*s, dtype=torch.bfloat16) * 0.05)(B, S, D)), 'w1': _w((lambda *s: torch.randn(*s, dtype=torch.bfloat16) * 3.2)(D, F) * D ** (-0.5)), 'w2': _w((lambda *s: torch.randn(*s, dtype=torch.bfloat16) * 0.4)(F, D) * F ** (-0.5))}
    _B_in = _B_setup()
    return {'A_x': _A_in['x'], 'A_wqkv': _A_in['wqkv'], 'A_wo': _A_in['wo'], 'B_x': _B_in['x'], 'B_w1': _B_in['w1'], 'B_w2': _B_in['w2'], 'c': _w((lambda *s: torch.randn(*s, dtype=torch.bfloat16) * 0.1)(1, 640) * 8.0), 'w_mod': _w((lambda *s: torch.randn(*s, dtype=torch.bfloat16) * 0.1)(640, 6 * 640) * 640 ** (-0.5) * 8.0)}

def reference(A_x, A_wqkv, A_wo, B_x, B_w1, B_w2, c, w_mod):

    def _A_ref(x, wqkv, wo):
        B, S, D = x.shape
        H = 32
        Dh = D // H
        W, dil = (8, 2)
        qkv = (lambda x, *d: x.permute(*d))((x @ wqkv).reshape(B, S, 3, H, Dh), 2, 0, 3, 1, 4)
        q, k, v = (qkv[0], qkv[1], qkv[2])
        scale = Dh ** (-0.5)
        pos = torch.arange(S)
        off = torch.arange(W) * dil
        idx = pos[:, None] - off[None, :]
        mask = idx >= 0
        idx_c = torch.where(mask, idx, 0).reshape(-1)
        kg = k[:, :, idx_c, :].reshape(B, H, S, W, Dh)
        vg = v[:, :, idx_c, :].reshape(B, H, S, W, Dh)
        logits = torch.einsum('bhsd,bhswd->bhsw', q, kg) * scale
        logits = torch.where(mask[None, None, :, :], logits, -1000000000.0)
        attn = _softmax(logits, axis=-1)
        o = torch.einsum('bhsw,bhswd->bhsd', attn, vg)
        return (lambda x, *d: x.permute(*d))(o, 0, 2, 1, 3).reshape(B, S, D) @ wo

    def _B_ref(x, w1, w2):
        h = torch.einsum('bsd,df->bsf', x, w1)
        h = _silu(h)
        out = torch.einsum('bsf,fd->bsd', h, w2)
        return out
    x = A_x
    mod = (_silu(c) @ w_mod).reshape(c.shape[0], 6, 1, -1)
    sa, ca, ga, sb, cb, gb = (mod[:, 0].clone(), mod[:, 1].clone(), mod[:, 2].clone(), mod[:, 3].clone(), mod[:, 4].clone(), mod[:, 5].clone())
    h = _layernorm(x, axis=-1) * (1 + ca) + sa
    x = x + ga * _A_ref(h, A_wqkv, A_wo)
    h = _layernorm(x, axis=-1) * (1 + cb) + sb
    x = x + gb * _B_ref(h, B_w1, B_w2)
    return x
```

```asm
; @launch grid=(256,1,1) block=(256,1,1) lds=163840
.amdgcn_target "amdgcn-amd-amdhsa--gfx950"
.text
.globl adaLN_cond__sliding_local_dilated__dense_activation_silu__prompt_kernel
.p2align 8
.type adaLN_cond__sliding_local_dilated__dense_activation_silu__prompt_kernel,@function
adaLN_cond__sliding_local_dilated__dense_activation_silu__prompt_kernel:
    s_cmp_ge_u32 s2, 256
    s_cbranch_scc1 L_end
    s_load_dwordx16 s[8:23], s[0:1], 0
    s_load_dwordx4 s[24:27], s[0:1], 64
    s_load_dwordx2 s[28:29], s[0:1], 80
    s_getpc_b64 s[52:53]
    s_and_b32 s53, s53, 0xffff
    s_mov_b32 s54, CODE_END-adaLN_cond__sliding_local_dilated__dense_activation_silu__prompt_kernel-64
    s_mov_b32 s55, 0x20000
    s_bfe_u32 s86, s2, 0x10003
    s_lshl_b32 s86, s86, 15
    v_lshl_add_u32 v1, v0, 7, s86
    buffer_load_dword v255, v1, s[52:55], 0 offen
    v_lshrrev_b32 v1, 6, v0
    v_and_b32 v0, 63, v0
    v_readfirstlane_b32 s3, v1
    v_lshlrev_b32 v1, 4, v0
    s_and_b32 s86, s2, 7
    s_lshr_b32 s87, s2, 7
    s_lshl1_add_u32 s4, s86, s87
    s_bfe_u32 s5, s2, 0x40003
    s_lshl4_add_u32 s7, s4, s5
    s_lshr_b32 s30, s5, 3
    s_and_b32 s31, s5, 7
    s_mov_b32 s95, 0x3f803f80
    s_mov_b32 s96, 0xffff0000
    s_mul_i32 s82, s3, 38400
    s_mul_i32 s84, s5, 153600
    s_add_u32 s84, s84, s82
    s_add_u32 s84, s84, 0x10a8000
    v_and_b32 v2, 15, v0
    v_lshrrev_b32 v3, 4, v0
    v_lshrrev_b32 v36, 5, v0
    v_bfe_u32 v37, v0, 3, 2
    v_lshl_add_u32 v36, v36, 3, v37
    v_and_b32 v37, 0x70, v1
    v_mul_u32_u24 v38, 7680, v36
    v_add_u32 v38, v38, v37
    v_mul_u32_u24 v39, 1280, v36
    v_add_u32 v39, v39, v37
    v_lshlrev_b32 v41, 2, v0
    v_mul_u32_u24 v6, 13, v0
    v_lshrrev_b32 v6, 8, v6
    v_mul_u32_u24 v6, 960, v6
    v_add_u32 v6, v6, v1
    v_mul_u32_u24 v43, 1280, v2
    v_lshl_add_u32 v43, v3, 4, v43
    s_lshr_b32 s88, s5, 1
    s_lshl3_add_u32 s89, s87, s88
    s_lshl3_add_u32 s89, s89, s86
    s_lshl3_add_u32 s83, s4, s88
    s_xor_b32 s87, s87, s5
    s_and_b32 s87, s87, 1
    s_sub_u32 s85, 0, s87
    s_cbranch_scc1 prod_1
    s_mul_i32 s86, s89, 205
    s_lshr_b32 s86, s86, 10
    s_mul_i32 s87, s86, 5
    s_sub_u32 s87, s89, s87
    s_lshl2_add_u32 s88, s87, s3
    s_lshl_b32 s92, s88, 6
    s_mul_i32 s91, s88, 245760
    s_lshl_b32 s90, s86, 7
    s_add_u32 s91, s91, s90
    s_mul_i32 s73, s87, 15360
    s_lshl1_add_u32 s73, s90, s73
    s_add_u32 s73, s73, 0x24000
    s_cmp_lt_u32 s89, 100
    s_cselect_b32 s72, -1, 0
    v_add_u32 v44, s92, v41
    s_sub_u32 s87, s89, 48
    s_cselect_b32 s97, 0, -1
    s_and_b32 s87, s87, s97
    s_lshr_b32 s86, s87, 2
    s_and_b32 s87, s87, 3
    s_lshl2_add_u32 s88, s86, s3
    s_mul_i32 s88, s88, 30720
    s_mul_i32 s90, s87, 320
    s_add_u32 s88, s88, s90
    s_lshl2_add_u32 s87, s87, s3
    s_mul_i32 s90, s87, 20
    s_add_u32 s90, s90, s86
    s_mul_i32 s70, s90, 7680
    s_add_u32 s70, s70, 0x10a8000
    s_lshl_b32 s87, s87, 5
    s_add_u32 s87, s87, s86
    s_lshl_b32 s71, s87, 7
    s_add_u32 s71, s71, 0x60000
    s_mul_i32 m0, s3, 7808
    s_waitcnt lgkmcnt(0)
    s_load_dword s6, s[28:29], 0
    s_mov_b32 s15, s89
    s_mov_b32 s48, s20
    s_and_b32 s49, s21, 0xffff
    s_mov_b32 s50, 1280
    s_mov_b32 s51, 0x20000
    buffer_load_dword v44, v44, s[48:51], 0 offen
    s_mov_b32 s52, s22
    s_and_b32 s53, s23, 0xffff
    s_mov_b32 s54, 4915200
    s_mov_b32 s55, 0x20000
    s_mov_b32 exec_lo, s72
    s_mov_b32 exec_hi, s72
    s_add_u32 s93, s91, 0
    buffer_load_dwordx4 v[176:179], v38, s[52:55], s93 offen nt
    s_add_u32 s93, s91, 122880
    buffer_load_dwordx4 v[180:183], v38, s[52:55], s93 offen nt
    s_add_u32 s93, s91, 30720
    buffer_load_dwordx4 v[184:187], v38, s[52:55], s93 offen nt
    s_add_u32 s93, s91, 153600
    buffer_load_dwordx4 v[188:191], v38, s[52:55], s93 offen nt
    s_mov_b64 exec, -1
    s_mov_b32 s36, s10
    s_and_b32 s37, s11, 0xffff
    s_mov_b32 s38, 2457600
    s_mov_b32 s39, 0x20000
    s_mov_b32 exec_lo, s97
    s_lshr_b32 exec_hi, s97, 4
    buffer_load_dwordx4 v6, s[36:39], s88 offen  lds
    s_add_u32 m0, m0, 976
    s_add_u32 s88, s88, 3840
    buffer_load_dwordx4 v6, s[36:39], s88 offen  lds
    s_add_u32 m0, m0, 976
    s_add_u32 s88, s88, 3840
    buffer_load_dwordx4 v6, s[36:39], s88 offen  lds
    s_add_u32 m0, m0, 976
    s_add_u32 s88, s88, 3840
    buffer_load_dwordx4 v6, s[36:39], s88 offen  lds
    s_add_u32 m0, m0, 976
    s_add_u32 s88, s88, 3840
    buffer_load_dwordx4 v6, s[36:39], s88 offen  lds
    s_add_u32 m0, m0, 976
    s_add_u32 s88, s88, 3840
    buffer_load_dwordx4 v6, s[36:39], s88 offen  lds
    s_add_u32 m0, m0, 976
    s_add_u32 s88, s88, 3840
    buffer_load_dwordx4 v6, s[36:39], s88 offen  lds
    s_add_u32 m0, m0, 976
    s_add_u32 s88, s88, 3840
    buffer_load_dwordx4 v6, s[36:39], s88 offen  lds
    s_mov_b64 exec, -1
    s_mov_b32 s40, s28
    s_and_b32 s41, s29, 0xffff
    s_mov_b32 s42, 20185344
    s_mov_b32 s43, 0x20000
    s_mov_b32 s32, s8
    s_and_b32 s33, s9, 0xffff
    s_mov_b32 s34, 2621440
    s_mov_b32 s35, 0x20000
    s_lshl_b32 s86, s3, 11
    s_add_u32 s86, s86, 153600
    v_and_b32 v42, 0x30, v0
    v_lshlrev_b32 v42, 1, v42
    v_xor_b32 v42, v42, v1
    v_add_u32 v42, s86, v42
    v_lshrrev_b32 v140, 2, v0
    v_and_b32 v141, 6, v140
    v_lshlrev_b32 v141, 4, v141
    v_lshl_add_u32 v140, v140, 7, v141
    v_and_b32 v141, 3, v0
    v_lshl_add_u32 v140, v141, 3, v140
    v_add_u32 v140, s86, v140
    v_xor_b32 v141, 32, v140
    v_xor_b32 v142, 64, v140
    v_xor_b32 v143, 96, v140
    v_add_u32 v41, s86, v41
    v_lshl_add_u32 v45, v3, 4, s86
    v_lshl_add_u32 v145, v3, 6, s86
    s_lshl_b32 s86, s3, 8
    s_add_u32 s86, s86, 162304
    v_lshl_add_u32 v144, v3, 4, s86
    v_lshlrev_b32 v146, 4, v2
    v_add_u32 v147, 162304, v146
    s_waitcnt lgkmcnt(0)
    s_add_u32 s6, s6, 0x9e3779b9
    s_mov_b32 s44, s24
    s_and_b32 s45, s25, 0xffff
    s_mov_b32 s46, 2621440
    s_mov_b32 s47, 0x20000
    v_min_u32 v7, 39, v0
    s_mul_i32 s86, s3, 40
    v_add_lshl_u32 v7, v7, s86, 4
    v_add_u32 v5, 4096, v1
    v_mov_b32 v8, v1
    v_and_b32 v149, 0x70, v1
    v_lshl_add_u32 v152, v3, 7, v149
    v_add_u32 v9, 38400, v8
    v_add_u32 v153, 38400, v152
    v_add_u32 v10, 76800, v8
    v_add_u32 v154, 76800, v152
    v_add_u32 v11, 115200, v8
    v_add_u32 v155, 115200, v152
    v_add_u32 v12, s82, v8
    v_add_u32 v156, s82, v152
    s_lshr_b32 s86, s3, 1
    s_mul_i32 s86, s86, 26112
    s_mul_i32 s87, s3, 6144
    s_add_u32 s86, s86, s87
    s_add_u32 s86, s86, 76800
    v_add_u32 v4, s86, v1
    s_cmp_eq_u32 s3, 1
    s_cselect_b32 s86, 512, 0
    v_or_b32 v157, s86, v1
    s_lshl_b32 s86, s3, 10
    s_add_u32 s86, s86, 76800
    v_add_u32 v157, s86, v157
    s_add_u32 s87, s3, 4
    s_min_u32 s87, s87, 5
    s_lshl_b32 s86, s87, 10
    s_add_u32 s86, s86, 76800
    v_add_u32 v158, s86, v1
    s_lshl_b32 s86, s3, 9
    s_add_u32 s86, s86, 89088
    v_lshl_add_u32 v159, v0, 3, s86
    s_lshl_b32 s86, s87, 9
    s_add_u32 s86, s86, 89088
    v_lshl_add_u32 v160, v0, 3, s86
    s_mul_i32 s86, s3, 3072
    s_add_u32 s86, s86, 89088
    v_lshl_add_u32 v161, v0, 3, s86
    v_and_b32 v148, 1, v3
    v_lshrrev_b32 v149, 1, v3
    v_mad_u32_u24 v162, v148, 3, v149
    v_lshlrev_b32 v150, 4, v2
    v_lshl_add_u32 v162, v162, 8, v150
    v_mul_u32_u24 v149, 20480, v149
    v_lshl_add_u32 v163, v148, 3, v150
    v_add_u32 v163, v163, v149
    s_or_b32 s86, s4, s3
    s_cselect_b32 s86, 0, 0xff61b1e6
    s_mov_b32 s87, 0x80000001
    s_mov_b32 s88, 0x80000000
    s_mov_b32 s89, 0x07070303
    v_mov_b32 v150, 0xff61b1e6
    v_lshlrev_b32 v148, 2, v3
    v_sub_u32 v148, v2, v148
    v_subrev_u32 v149, 0, v148
    v_and_b32 v149, s87, v149
    v_cmp_ne_u32 vcc, 0, v149
    s_nop 1
    v_cndmask_b32 v16, 0, v150, vcc
    v_cmp_ne_u32 vcc, s88, v149
    s_nop 1
    v_cndmask_b32 v20, 0, v150, vcc
    v_or_b32 v24, s86, v20
    v_subrev_u32 v149, 1, v148
    v_and_b32 v149, s87, v149
    v_cmp_ne_u32 vcc, 0, v149
    s_nop 1
    v_cndmask_b32 v17, 0, v150, vcc
    v_cmp_ne_u32 vcc, s88, v149
    s_nop 1
    v_cndmask_b32 v21, 0, v150, vcc
    v_or_b32 v25, s86, v21
    v_subrev_u32 v149, 2, v148
    v_and_b32 v149, s87, v149
    v_cmp_ne_u32 vcc, 0, v149
    s_nop 1
    v_cndmask_b32 v18, 0, v150, vcc
    v_cmp_ne_u32 vcc, s88, v149
    s_nop 1
    v_cndmask_b32 v22, 0, v150, vcc
    v_or_b32 v26, s86, v22
    v_subrev_u32 v149, 3, v148
    v_and_b32 v149, s87, v149
    v_cmp_ne_u32 vcc, 0, v149
    s_nop 1
    v_cndmask_b32 v19, 0, v150, vcc
    v_cmp_ne_u32 vcc, s88, v149
    s_nop 1
    v_cndmask_b32 v23, 0, v150, vcc
    v_or_b32 v27, s86, v23
    v_perm_b32 v28, v21, v20, s89
    v_perm_b32 v29, v23, v22, s89
    v_perm_b32 v30, v17, v16, s89
    v_perm_b32 v31, v19, v18, s89
    s_lshl2_add_u32 s86, s4, s3
    s_mul_i32 s86, s86, 40960
    s_add_u32 s56, s86, 0xe28000
    s_add_u32 s57, s86, 0xe29400
    s_add_u32 s58, s86, 0xe2a800
    s_add_u32 s59, s86, 0xe2bc00
    s_add_u32 s60, s86, 0xe2d000
    s_add_u32 s61, s86, 0xe2e400
    s_add_u32 s62, s86, 0xe2f800
    s_add_u32 s63, s86, 0xe30c00
    s_mul_i32 s87, s5, 1280
    s_add_u32 s65, s86, s87
    s_add_u32 s65, s65, 0x328000
    s_lshl_b32 s86, s4, 3
    s_max_u32 s87, s86, 1
    s_sub_u32 s87, s87, 1
    s_lshl2_add_u32 s88, s87, s3
    s_mul_i32 s88, s88, 5120
    s_add_u32 s64, s88, 0xe28000
    s_lshl1_add_u32 s86, s3, s86
    v_add_u32 v13, s86, v0
    v_mov_b32 v148, s87
    v_cmp_gt_u32 vcc, 2, v0
    s_nop 1
    v_cndmask_b32 v13, v148, v13, vcc
    v_lshlrev_b32 v13, 7, v13
    s_mul_i32 s88, s31, 5120
    s_mul_i32 s89, s3, 204800
    s_add_u32 s66, s88, s89
    s_add_u32 s66, s66, 0x80000
    s_mul_i32 s89, s3, 491520
    s_add_u32 s69, s88, s89
    s_add_u32 s69, s69, 0x148000
    s_mov_b32 s48, s16
    s_and_b32 s49, s17, 0xffff
    s_mov_b32 s50, 1966080
    s_mov_b32 s51, 0x20000
    s_mul_i32 s68, s3, 3072
    s_mul_i32 s89, s5, 192
    s_lshl4_add_u32 s67, s68, s89
    v_add_u32 v148, 0, v0
    v_mul_u32_u24 v149, 171, v148
    v_lshrrev_b32 v149, 11, v149
    v_mul_u32_u24 v150, 12, v149
    v_sub_u32 v148, v148, v150
    v_lshrrev_b32 v150, 2, v149
    v_and_b32 v150, 2, v150
    v_xor_b32 v148, v148, v150
    v_mul_u32_u24 v149, 3072, v149
    v_lshl_add_u32 v164, v148, 4, v149
    v_add_u32 v148, 64, v0
    v_mul_u32_u24 v149, 171, v148
    v_lshrrev_b32 v149, 11, v149
    v_mul_u32_u24 v150, 12, v149
    v_sub_u32 v148, v148, v150
    v_lshrrev_b32 v150, 2, v149
    v_and_b32 v150, 2, v150
    v_xor_b32 v148, v148, v150
    v_mul_u32_u24 v149, 3072, v149
    v_lshl_add_u32 v165, v148, 4, v149
    v_subrev_u32 v165, 1024, v165
    v_add_u32 v148, 128, v0
    v_mul_u32_u24 v149, 171, v148
    v_lshrrev_b32 v149, 11, v149
    v_mul_u32_u24 v150, 12, v149
    v_sub_u32 v148, v148, v150
    v_lshrrev_b32 v150, 2, v149
    v_and_b32 v150, 2, v150
    v_xor_b32 v148, v148, v150
    v_mul_u32_u24 v149, 3072, v149
    v_lshl_add_u32 v166, v148, 4, v149
    v_subrev_u32 v166, 2048, v166
    s_waitcnt vmcnt(12)
    v_lshlrev_b32 v46, 16, v44
    v_and_b32 v47, s96, v44
    v_mul_f32 v48, 0xbfb8aa3b, v46
    v_mul_f32 v49, 0xbfb8aa3b, v47
    v_exp_f32 v48, v48
    v_exp_f32 v49, v49
    v_add_f32 v48, 1.0, v48
    v_add_f32 v49, 1.0, v49
    v_rcp_f32 v48, v48
    v_rcp_f32 v49, v49
    v_mul_f32 v46, v46, v48
    v_mul_f32 v47, v47, v49
    v_cvt_pk_bf16_f32 v44, v46, v47
    ds_write_b32 v41, v44
    ds_read_b128 v[112:115], v45 offset:0
    s_mul_i32 s86, s3, 80
    v_lshrrev_b32 v216, 2, v0
    v_mul_u32_u24 v216, 1952, v216
    v_and_b32 v217, 3, v0
    v_lshl_add_u32 v216, v217, 3, v216
    v_add_u32 v216, s86, v216
    v_and_b32 v217, 2, v0
    v_mul_u32_u24 v217, 152, v217
    v_add_u32 v217, v217, v216
    v_add_u32 v218, 4096, v152
    s_waitcnt vmcnt(0)
    s_barrier
    ds_read_b64_tr_b16 v[220:221], v216 offset:0
    ds_read_b64_tr_b16 v[222:223], v216 offset:976
    ds_read_b64_tr_b16 v[224:225], v216 offset:48
    ds_read_b64_tr_b16 v[226:227], v216 offset:1024
    ds_read_b64_tr_b16 v[228:229], v216 offset:320
    ds_read_b64_tr_b16 v[230:231], v216 offset:1296
    ds_read_b64_tr_b16 v[232:233], v216 offset:368
    ds_read_b64_tr_b16 v[234:235], v216 offset:1344
    ds_read_b64_tr_b16 v[236:237], v217 offset:32
    ds_read_b64_tr_b16 v[238:239], v217 offset:1008
    ds_read_b64_tr_b16 v[240:241], v216 offset:640
    ds_read_b64_tr_b16 v[242:243], v216 offset:1616
    ds_read_b64_tr_b16 v[244:245], v216 offset:688
    ds_read_b64_tr_b16 v[246:247], v216 offset:1664
    ds_read_b64_tr_b16 v[248:249], v216 offset:672
    ds_read_b64_tr_b16 v[250:251], v216 offset:1648
    s_waitcnt lgkmcnt(14)
    v_lshlrev_b32 v212, 16, v220
    v_and_b32 v220, s96, v220
    v_lshlrev_b32 v213, 16, v221
    v_and_b32 v221, s96, v221
    v_lshlrev_b32 v214, 16, v222
    v_and_b32 v222, s96, v222
    v_lshlrev_b32 v215, 16, v223
    v_and_b32 v223, s96, v223
    v_cvt_pk_f16_f32 v220, v212, v220
    v_cvt_pk_f16_f32 v221, v213, v221
    v_cvt_pk_f16_f32 v222, v214, v222
    v_cvt_pk_f16_f32 v223, v215, v223
    s_mov_b32 exec_lo, s97
    s_mov_b32 exec_hi, s97
    buffer_store_dwordx4 v[220:223], v1, s[40:43], s70 offen offset:0 sc1
    s_mov_b64 exec, -1
    s_waitcnt lgkmcnt(12)
    v_lshlrev_b32 v212, 16, v224
    v_and_b32 v224, s96, v224
    v_lshlrev_b32 v213, 16, v225
    v_and_b32 v225, s96, v225
    v_lshlrev_b32 v214, 16, v226
    v_and_b32 v226, s96, v226
    v_lshlrev_b32 v215, 16, v227
    v_and_b32 v227, s96, v227
    v_cvt_pk_f16_f32 v224, v212, v224
    v_cvt_pk_f16_f32 v225, v213, v225
    v_cvt_pk_f16_f32 v226, v214, v226
    v_cvt_pk_f16_f32 v227, v215, v227
    s_mov_b32 exec_lo, s97
    s_mov_b32 exec_hi, s97
    buffer_store_dwordx4 v[224:227], v1, s[40:43], s70 offen offset:1024 sc1
    s_mov_b64 exec, -1
    s_waitcnt lgkmcnt(10)
    v_lshlrev_b32 v212, 16, v228
    v_and_b32 v228, s96, v228
    v_lshlrev_b32 v213, 16, v229
    v_and_b32 v229, s96, v229
    v_lshlrev_b32 v214, 16, v230
    v_and_b32 v230, s96, v230
    v_lshlrev_b32 v215, 16, v231
    v_and_b32 v231, s96, v231
    v_cvt_pk_f16_f32 v228, v212, v228
    v_cvt_pk_f16_f32 v229, v213, v229
    v_cvt_pk_f16_f32 v230, v214, v230
    v_cvt_pk_f16_f32 v231, v215, v231
    s_mov_b32 exec_lo, s97
    s_mov_b32 exec_hi, s97
    buffer_store_dwordx4 v[228:231], v1, s[40:43], s70 offen offset:2048 sc1
    s_mov_b64 exec, -1
    s_waitcnt lgkmcnt(8)
    v_lshlrev_b32 v212, 16, v232
    v_and_b32 v232, s96, v232
    v_lshlrev_b32 v213, 16, v233
    v_and_b32 v233, s96, v233
    v_lshlrev_b32 v214, 16, v234
    v_and_b32 v234, s96, v234
    v_lshlrev_b32 v215, 16, v235
    v_and_b32 v235, s96, v235
    v_cvt_pk_f16_f32 v232, v212, v232
    v_cvt_pk_f16_f32 v233, v213, v233
    v_cvt_pk_f16_f32 v234, v214, v234
    v_cvt_pk_f16_f32 v235, v215, v235
    s_mov_b32 exec_lo, s97
    s_mov_b32 exec_hi, s97
    buffer_store_dwordx4 v[232:235], v1, s[40:43], s70 offen offset:3072 sc1
    s_mov_b64 exec, -1
    s_waitcnt lgkmcnt(6)
    v_lshlrev_b32 v212, 16, v236
    v_and_b32 v236, s96, v236
    v_lshlrev_b32 v213, 16, v237
    v_and_b32 v237, s96, v237
    v_lshlrev_b32 v214, 16, v238
    v_and_b32 v238, s96, v238
    v_lshlrev_b32 v215, 16, v239
    v_and_b32 v239, s96, v239
    v_cvt_pk_f16_f32 v236, v212, v236
    v_cvt_pk_f16_f32 v237, v213, v237
    v_cvt_pk_f16_f32 v238, v214, v238
    v_cvt_pk_f16_f32 v239, v215, v239
    s_mov_b32 exec_lo, s97
    s_mov_b32 exec_hi, s97
    buffer_store_dwordx4 v[236:239], v5, s[40:43], s70 offen offset:0 sc1
    s_mov_b64 exec, -1
    s_waitcnt lgkmcnt(4)
    v_lshlrev_b32 v212, 16, v240
    v_and_b32 v240, s96, v240
    v_lshlrev_b32 v213, 16, v241
    v_and_b32 v241, s96, v241
    v_lshlrev_b32 v214, 16, v242
    v_and_b32 v242, s96, v242
    v_lshlrev_b32 v215, 16, v243
    v_and_b32 v243, s96, v243
    v_cvt_pk_f16_f32 v240, v212, v240
    v_cvt_pk_f16_f32 v241, v213, v241
    v_cvt_pk_f16_f32 v242, v214, v242
    v_cvt_pk_f16_f32 v243, v215, v243
    s_mov_b32 exec_lo, s97
    s_mov_b32 exec_hi, s97
    buffer_store_dwordx4 v[240:243], v5, s[40:43], s70 offen offset:1024 sc1
    s_mov_b64 exec, -1
    s_waitcnt lgkmcnt(2)
    v_lshlrev_b32 v212, 16, v244
    v_and_b32 v244, s96, v244
    v_lshlrev_b32 v213, 16, v245
    v_and_b32 v245, s96, v245
    v_lshlrev_b32 v214, 16, v246
    v_and_b32 v246, s96, v246
    v_lshlrev_b32 v215, 16, v247
    v_and_b32 v247, s96, v247
    v_cvt_pk_f16_f32 v244, v212, v244
    v_cvt_pk_f16_f32 v245, v213, v245
    v_cvt_pk_f16_f32 v246, v214, v246
    v_cvt_pk_f16_f32 v247, v215, v247
    s_mov_b32 exec_lo, s97
    s_mov_b32 exec_hi, s97
    buffer_store_dwordx4 v[244:247], v5, s[40:43], s70 offen offset:2048 sc1
    s_mov_b64 exec, -1
    s_waitcnt lgkmcnt(0)
    v_lshlrev_b32 v212, 16, v248
    v_and_b32 v248, s96, v248
    v_lshlrev_b32 v213, 16, v249
    v_and_b32 v249, s96, v249
    v_lshlrev_b32 v214, 16, v250
    v_and_b32 v250, s96, v250
    v_lshlrev_b32 v215, 16, v251
    v_and_b32 v251, s96, v251
    v_cvt_pk_f16_f32 v248, v212, v248
    v_cvt_pk_f16_f32 v249, v213, v249
    v_cvt_pk_f16_f32 v250, v214, v250
    v_cvt_pk_f16_f32 v251, v215, v251
    s_and_b32 exec_lo, s97, 0x00ff00ff
    s_mov_b32 exec_hi, exec_lo
    buffer_store_dwordx4 v[248:251], v218, s[40:43], s70 offen offset:3072 sc1
    s_mov_b64 exec, -1
    ds_write_b128 v42, v[176:179] offset:0
    ds_write_b128 v42, v[180:183] offset:1024
    ds_read_b64_tr_b16 v[96:97], v140
    ds_read_b64_tr_b16 v[100:101], v141
    ds_read_b64_tr_b16 v[104:105], v142
    ds_read_b64_tr_b16 v[108:109], v143
    ds_write_b128 v42, v[184:187] offset:0
    ds_write_b128 v42, v[188:191] offset:1024
    ds_read_b64_tr_b16 v[98:99], v140
    ds_read_b64_tr_b16 v[102:103], v141
    ds_read_b64_tr_b16 v[106:107], v142
    ds_read_b64_tr_b16 v[110:111], v143
    s_waitcnt lgkmcnt(0)
    v_mfma_f32_16x16x32_bf16 v[60:63], v[96:99], v[112:115], 0
    v_mfma_f32_16x16x32_bf16 v[64:67], v[100:103], v[112:115], 0
    v_mfma_f32_16x16x32_bf16 v[68:71], v[104:107], v[112:115], 0
    v_mfma_f32_16x16x32_bf16 v[72:75], v[108:111], v[112:115], 0
    s_mov_b32 exec_lo, 0x00010001
    s_mov_b32 exec_hi, 0x00010001
    s_nop 6
    ds_write_b128 v144, v[60:63] offset:0
    ds_write_b128 v144, v[64:67] offset:64
    ds_write_b128 v144, v[68:71] offset:128
    ds_write_b128 v144, v[72:75] offset:192
    s_mov_b64 exec, -1
    s_waitcnt lgkmcnt(0)
    s_barrier
    s_cmp_eq_u32 s72, 0
    s_cselect_b32 s91, 1, s3
    s_cmp_lg_u32 s91, 0
    s_cselect_b32 s91, 0, 0xffff
    s_cbranch_scc1 nomod_3
    ds_read_b128 v[60:63], v147 offset:0
    ds_read_b128 v[64:67], v147 offset:256
    ds_read_b128 v[68:71], v147 offset:512
    ds_read_b128 v[72:75], v147 offset:768
    s_mov_b32 s86, 0xffffff00
    s_bfe_u32 s87, s6, 0x80000
    s_bfe_u32 s88, s6, 0x80008
    s_bfe_u32 s89, s6, 0x80010
    s_bfe_u32 s90, s6, 0x80018
    s_waitcnt lgkmcnt(0)
    v_pk_add_f32 v[60:61], v[60:61], v[64:65]
    v_pk_add_f32 v[68:69], v[68:69], v[72:73]
    v_pk_add_f32 v[62:63], v[62:63], v[66:67]
    v_pk_add_f32 v[70:71], v[70:71], v[74:75]
    v_pk_add_f32 v[60:61], v[60:61], v[68:69]
    v_pk_add_f32 v[62:63], v[62:63], v[70:71]
    v_and_b32 v60, s86, v60
    v_and_b32 v61, s86, v61
    v_and_b32 v62, s86, v62
    v_and_b32 v63, s86, v63
    v_or_b32 v60, s87, v60
    v_or_b32 v61, s88, v61
    v_or_b32 v62, s89, v62
    v_or_b32 v63, s90, v63
nomod_3:
    s_mov_b32 exec_lo, s91
    s_mov_b32 exec_hi, 0
    buffer_store_dwordx4 v[60:63], v146, s[40:43], s73 offen sc1
    s_mov_b64 exec, -1
    v_mov_b32 v14, s6
    s_and_b32 exec_lo, s97, 1
    s_mov_b32 exec_hi, 0
    s_waitcnt vmcnt(1)
    buffer_store_dword v14, off, s[40:43], s71 sc1
    s_mov_b64 exec, -1
    s_mov_b32 s97, 0
    s_mov_b64 s[70:71], 0xffff
    s_mov_b32 s72, 0xffff0000
    s_mov_b32 s73, 0
    s_lshl_b32 s92, s5, 12
    s_mul_i32 s86, s3, 640
    s_add_u32 s92, s92, s86
    s_add_u32 s92, s92, 0x60000
    v_and_b32 v50, 7, v0
    v_min_u32 v50, 4, v50
    v_lshlrev_b32 v50, 7, v50
    v_add_u32 v50, s92, v50
    v_add_u32 v13, 0x1a000, v13
    v_cmp_gt_u32 vcc, 32, v0
    s_nop 1
    v_cndmask_b32 v50, v50, v13, vcc
    s_mov_b32 s94, 0x8000
    buffer_load_dword v51, v50, s[40:43], 0 offen sc1
    s_mul_i32 s86, s3, 1408
    s_add_u32 s86, s86, 153600
    v_and_b32 v33, 16, v7
    v_sub_u32 v34, v7, v33
    v_lshrrev_b32 v33, 2, v33
    v_add3_u32 v33, v33, v34, s86
    v_lshlrev_b32 v167, 5, v3
    v_add_u32 v167, 153600, v167
    s_lshl_b32 s86, s3, 11
    v_add_u32 v6, s86, v167
    s_mov_b32 s91, 0
    s_waitcnt vmcnt(0)
cfp_4:
    v_cmp_ne_u32 vcc, s6, v51
    s_cmp_eq_u32 vcc_hi, 0
    s_cbranch_scc1 cfd_5
    buffer_load_dword v51, v50, s[40:43], 0 offen sc1
    s_sub_u32 s94, s94, 1
    s_cmp_lg_u32 s94, 0
    s_waitcnt vmcnt(0)
    s_cbranch_scc1 cfp_4
cfd_5:
    s_mov_b32 s86, 0x24000
    buffer_load_dwordx4 v[52:55], v7, s[40:43], s86 offen sc1
    s_mov_b32 s86, 0x27c00
    buffer_load_dwordx4 v[56:59], v7, s[40:43], s86 offen sc1
    s_mov_b32 s86, 0x2b800
    buffer_load_dwordx4 v[60:63], v7, s[40:43], s86 offen sc1
    s_mov_b32 s86, 0x2f400
    buffer_load_dwordx4 v[64:67], v7, s[40:43], s86 offen sc1
    s_mov_b32 s86, 0x33000
    buffer_load_dwordx4 v[68:71], v7, s[40:43], s86 offen sc1
    s_mov_b32 s86, 0x24a00
    buffer_load_dwordx4 v[72:75], v7, s[40:43], s86 offen sc1
    s_mov_b32 s86, 0x28600
    buffer_load_dwordx4 v[76:79], v7, s[40:43], s86 offen sc1
    s_mov_b32 s86, 0x2c200
    buffer_load_dwordx4 v[80:83], v7, s[40:43], s86 offen sc1
    s_mov_b32 s86, 0x2fe00
    buffer_load_dwordx4 v[84:87], v7, s[40:43], s86 offen sc1
    s_mov_b32 s86, 0x33a00
    buffer_load_dwordx4 v[88:91], v7, s[40:43], s86 offen sc1
    s_add_u32 m0, s82, 0
    s_add_u32 s93, s84, 0
    buffer_load_dwordx4 v1, s[40:43], s93 offen offset:0 sc1 lds
    buffer_load_dwordx4 v1, s[40:43], s93 offen offset:1024 sc1 lds
    buffer_load_dwordx4 v1, s[40:43], s93 offen offset:2048 sc1 lds
    buffer_load_dwordx4 v1, s[40:43], s93 offen offset:3072 sc1 lds
    s_add_u32 m0, s82, 4096
    s_add_u32 s93, s84, 4096
    buffer_load_dwordx4 v1, s[40:43], s93 offen offset:0 sc1 lds
    buffer_load_dwordx4 v1, s[40:43], s93 offen offset:1024 sc1 lds
    buffer_load_dwordx4 v1, s[40:43], s93 offen offset:2048 sc1 lds
    buffer_load_dwordx4 v1, s[40:43], s93 offen offset:3072 sc1 lds
    s_cmp_eq_u32 vcc_lo, 0
    s_cbranch_scc1 fxok_6
    s_mov_b32 s94, 0x8000
poll_7:
    buffer_load_dword v32, v13, s[40:43], s91 offen sc1
    s_waitcnt vmcnt(0)
    v_cmp_ne_u32 vcc, s6, v32
    s_cbranch_vccz pdone_8
    s_sub_u32 s94, s94, 1
    s_cmp_lg_u32 s94, 0
    s_cbranch_scc1 poll_7
pdone_8:
fxok_6:
    buffer_load_dwordx4 v[220:223], v1, s[40:43], s56 offen offset:0 sc1
    buffer_load_dwordx4 v[224:227], v1, s[40:43], s60 offen offset:0 sc1
    buffer_load_dwordx4 v[200:203], v1, s[40:43], s64 offen offset:0 sc1
    buffer_load_dwordx4 v[228:231], v1, s[40:43], s57 offen offset:0 sc1
    buffer_load_dwordx4 v[232:235], v1, s[40:43], s61 offen offset:0 sc1
    s_mov_b32 s94, 0x8000
    s_bfe_u32 s87, s6, 0x80000
    s_bfe_u32 s88, s6, 0x80008
    s_bfe_u32 s89, s6, 0x80010
    s_bfe_u32 s90, s6, 0x80018
    s_waitcnt vmcnt(13)
mchk_9:
    v_xor_b32 v52, s87, v52
    v_xor_b32 v53, s88, v53
    v_or_b32 v36, v52, v53
    v_xor_b32 v54, s89, v54
    v_xor_b32 v55, s90, v55
    v_or3_b32 v36, v36, v54, v55
    v_xor_b32 v56, s87, v56
    v_xor_b32 v57, s88, v57
    v_or3_b32 v36, v36, v56, v57
    v_xor_b32 v58, s89, v58
    v_xor_b32 v59, s90, v59
    v_or3_b32 v36, v36, v58, v59
    v_xor_b32 v60, s87, v60
    v_xor_b32 v61, s88, v61
    v_or3_b32 v36, v36, v60, v61
    v_xor_b32 v62, s89, v62
    v_xor_b32 v63, s90, v63
    v_or3_b32 v36, v36, v62, v63
    v_xor_b32 v64, s87, v64
    v_xor_b32 v65, s88, v65
    v_or3_b32 v36, v36, v64, v65
    v_xor_b32 v66, s89, v66
    v_xor_b32 v67, s90, v67
    v_or3_b32 v36, v36, v66, v67
    v_xor_b32 v68, s87, v68
    v_xor_b32 v69, s88, v69
    v_or3_b32 v36, v36, v68, v69
    v_xor_b32 v70, s89, v70
    v_xor_b32 v71, s90, v71
    v_or3_b32 v36, v36, v70, v71
    v_xor_b32 v72, s87, v72
    v_xor_b32 v73, s88, v73
    v_or3_b32 v36, v36, v72, v73
    v_xor_b32 v74, s89, v74
    v_xor_b32 v75, s90, v75
    v_or3_b32 v36, v36, v74, v75
    v_xor_b32 v76, s87, v76
    v_xor_b32 v77, s88, v77
    v_or3_b32 v36, v36, v76, v77
    v_xor_b32 v78, s89, v78
    v_xor_b32 v79, s90, v79
    v_or3_b32 v36, v36, v78, v79
    v_xor_b32 v80, s87, v80
    v_xor_b32 v81, s88, v81
    v_or3_b32 v36, v36, v80, v81
    v_xor_b32 v82, s89, v82
    v_xor_b32 v83, s90, v83
    v_or3_b32 v36, v36, v82, v83
    v_xor_b32 v84, s87, v84
    v_xor_b32 v85, s88, v85
    v_or3_b32 v36, v36, v84, v85
    v_xor_b32 v86, s89, v86
    v_xor_b32 v87, s90, v87
    v_or3_b32 v36, v36, v86, v87
    v_xor_b32 v88, s87, v88
    v_xor_b32 v89, s88, v89
    v_or3_b32 v36, v36, v88, v89
    v_xor_b32 v90, s89, v90
    v_xor_b32 v91, s90, v91
    v_or3_b32 v36, v36, v90, v91
    v_cmp_ne_u32_sdwa vcc, v36, v0 src0_sel:BYTE_0 src1_sel:BYTE_3
    s_cbranch_vccnz mcold_10
mok_11:
    v_pk_add_f32 v[52:53], v[52:53], v[56:57]
    v_pk_add_f32 v[54:55], v[54:55], v[58:59]
    v_pk_add_f32 v[72:73], v[72:73], v[76:77]
    v_pk_add_f32 v[74:75], v[74:75], v[78:79]
    v_pk_add_f32 v[52:53], v[52:53], v[60:61]
    v_pk_add_f32 v[54:55], v[54:55], v[62:63]
    v_pk_add_f32 v[72:73], v[72:73], v[80:81]
    v_pk_add_f32 v[74:75], v[74:75], v[82:83]
    v_pk_add_f32 v[52:53], v[52:53], v[64:65]
    v_pk_add_f32 v[54:55], v[54:55], v[66:67]
    v_pk_add_f32 v[72:73], v[72:73], v[84:85]
    v_pk_add_f32 v[74:75], v[74:75], v[86:87]
    v_pk_add_f32 v[52:53], v[52:53], v[68:69]
    v_pk_add_f32 v[54:55], v[54:55], v[70:71]
    v_pk_add_f32 v[72:73], v[72:73], v[88:89]
    v_pk_add_f32 v[74:75], v[74:75], v[90:91]
    v_cvt_pk_bf16_f32 v52, v52, v53
    v_cvt_pk_bf16_f32 v53, v54, v55
    v_cvt_pk_bf16_f32 v72, v72, v73
    v_cvt_pk_bf16_f32 v73, v74, v75
    v_lshlrev_b32 v76, 16, v72
    v_and_b32 v77, s96, v72
    v_lshlrev_b32 v78, 16, v73
    v_and_b32 v79, s96, v73
    v_add_f32 v76, 1.0, v76
    v_add_f32 v77, 1.0, v77
    v_add_f32 v78, 1.0, v78
    v_add_f32 v79, 1.0, v79
    v_cvt_pk_bf16_f32 v72, v76, v77
    v_cvt_pk_bf16_f32 v73, v78, v79
    v_lshlrev_b32 v40, 16, v52
    v_and_b32 v41, s96, v52
    v_lshlrev_b32 v42, 16, v53
    v_and_b32 v43, s96, v53
    v_lshlrev_b32 v44, 16, v72
    v_and_b32 v45, s96, v72
    v_lshlrev_b32 v46, 16, v73
    v_and_b32 v47, s96, v73
    v_cvt_pk_f16_f32 v36, v44, v46
    v_cvt_pk_f16_f32 v37, v45, v47
    v_cvt_pk_f16_f32 v38, v40, v42
    v_cvt_pk_f16_f32 v39, v41, v43
    ds_write2_b32 v33, v36, v37 offset0:0 offset1:2
    ds_write2_b32 v33, v38, v39 offset0:4 offset1:6
    buffer_load_dwordx4 v[236:239], v1, s[40:43], s58 offen offset:0 sc1
    s_add_u32 m0, s82, 8192
    s_add_u32 s93, s84, 8192
    buffer_load_dwordx4 v1, s[40:43], s93 offen offset:0 sc1 lds
    buffer_load_dwordx4 v[240:243], v1, s[40:43], s62 offen offset:0 sc1
    buffer_load_dwordx4 v1, s[40:43], s93 offen offset:1024 sc1 lds
    buffer_load_dwordx4 v[244:247], v1, s[40:43], s59 offen offset:0 sc1
    buffer_load_dwordx4 v1, s[40:43], s93 offen offset:2048 sc1 lds
    buffer_load_dwordx4 v[248:251], v1, s[40:43], s63 offen offset:0 sc1
    buffer_load_dwordx4 v1, s[40:43], s93 offen offset:3072 sc1 lds
    s_add_u32 m0, s82, 12288
    s_add_u32 s93, s84, 12288
    buffer_load_dwordx4 v1, s[40:43], s93 offen offset:0 sc1 lds
    buffer_load_dwordx4 v1, s[40:43], s93 offen offset:1024 sc1 lds
    s_mov_b64 exec, 0
    buffer_store_dword v1, v1, s[40:43], 0 offen
    buffer_store_dword v1, v1, s[40:43], 0 offen
    buffer_store_dword v1, v1, s[40:43], 0 offen
    buffer_store_dword v1, v1, s[40:43], 0 offen
    buffer_store_dword v1, v1, s[40:43], 0 offen
    buffer_store_dword v1, v1, s[40:43], 0 offen
    buffer_store_dword v1, v1, s[40:43], 0 offen
    buffer_store_dword v1, v1, s[40:43], 0 offen
    buffer_store_dword v1, v1, s[40:43], 0 offen
    buffer_store_dword v1, v1, s[40:43], 0 offen
    buffer_store_dword v1, v1, s[40:43], 0 offen
    buffer_store_dword v1, v1, s[40:43], 0 offen
    buffer_store_dword v1, v1, s[40:43], 0 offen
    s_mov_b64 exec, -1
    buffer_load_dwordx4 v1, s[40:43], s93 offen offset:2048 sc1 lds
    s_waitcnt vmcnt(26)
    s_waitcnt lgkmcnt(0)
    s_branch join_2
prod_1:
    s_mul_i32 s91, s83, 20480
    s_mul_i32 s87, s3, 320
    s_add_u32 s91, s91, s87
    s_waitcnt lgkmcnt(0)
    s_load_dword s6, s[28:29], 0
    s_mov_b32 s32, s8
    s_and_b32 s33, s9, 0xffff
    s_mov_b32 s34, 2621440
    s_mov_b32 s35, 0x20000
    buffer_load_dwordx4 v[76:79], v43, s[32:35], s91 offen offset:0
    buffer_load_dwordx4 v[80:83], v43, s[32:35], s91 offen offset:64
    buffer_load_dwordx4 v[84:87], v43, s[32:35], s91 offen offset:128
    buffer_load_dwordx4 v[88:91], v43, s[32:35], s91 offen offset:192
    buffer_load_dwordx4 v[92:95], v43, s[32:35], s91 offen offset:256
    s_mov_b32 s15, s89
    s_mov_b32 s48, s20
    s_and_b32 s49, s21, 0xffff
    s_mov_b32 s50, 1280
    s_mov_b32 s51, 0x20000
    s_lshr_b32 s86, s15, 1
    s_and_b32 s87, s15, 1
    s_sub_u32 s80, 3, s87
    s_mul_i32 s88, s80, s3
    s_mul_i32 s90, s87, 12
    s_add_u32 s88, s88, s90
    s_lshl_b32 s92, s88, 6
    v_lshl_add_u32 v52, v0, 2, s92
    s_mul_i32 s92, s88, 245760
    s_lshl_b32 s90, s86, 7
    s_add_u32 s90, s90, 2560
    s_add_u32 s92, s92, s90
    s_mul_i32 s81, s87, 15360
    s_lshl1_add_u32 s81, s90, s81
    s_add_u32 s81, s81, 0x24000
    s_sub_u32 s86, s86, 2
    s_mul_i32 s87, s15, 3
    s_sub_u32 s87, s87, 200
    s_cmp_lt_u32 s15, 80
    s_cselect_b32 s80, s80, 0
    s_cselect_b32 s86, s86, s87
    s_mov_b32 s100, s86
    s_mov_b32 s101, s92
    buffer_load_dword v52, v52, s[48:51], 0 offen
    s_mov_b32 s55, 0x20000
    s_add_u32 s87, s100, 0
    s_lshl2_add_u32 s89, s87, s3
    s_mul_i32 s90, s89, 6554
    s_lshr_b32 s90, s90, 16
    s_mul_i32 s88, s90, 10
    s_sub_u32 s89, s89, s88
    s_lshr_b32 s88, s90, 2
    s_mul_i32 s90, s90, 40960
    s_lshl_b32 s74, s89, 12
    s_add_u32 s74, s74, s90
    s_add_u32 s74, s74, 0x80000
    s_lshl_b32 s89, s89, 7
    s_add_u32 s90, s90, s89
    s_sub_u32 s89, s90, 819200
    s_cmp_lt_u32 s87, 170
    s_cselect_b32 s77, -1, 0
    s_cmp_lt_u32 s88, 5
    s_cselect_b32 s52, s12, s18
    s_cselect_b32 s53, s13, s19
    s_cselect_b32 s88, 5, 12
    s_cselect_b32 s90, s90, s89
    s_cmp_gt_u32 s80, 0
    s_cselect_b32 s52, s22, s52
    s_cselect_b32 s53, s23, s53
    s_cselect_b32 s88, 30, s88
    s_cselect_b32 s90, s101, s90
    s_cselect_b32 s89, 6, 1
    s_cselect_b32 s87, -1, s77
    s_cselect_b32 s77, 0, s77
    s_cselect_b64 vcc, -1, 0
    s_and_b32 s53, s53, 0xffff
    s_mul_i32 s54, s88, 163840
    s_mul_i32 s89, s89, 1280
    v_cndmask_b32 v40, v39, v38, vcc
    s_mov_b32 exec_lo, s87
    s_mov_b32 exec_hi, s87
    s_mul_i32 s93, s89, 0
    s_add_u32 s93, s93, s90
    buffer_load_dwordx4 a[0:3], v40, s[52:55], s93 offen nt
    s_mul_i32 s93, s89, 16
    s_add_u32 s93, s93, s90
    buffer_load_dwordx4 a[4:7], v40, s[52:55], s93 offen nt
    s_mul_i32 s93, s89, 4
    s_add_u32 s93, s93, s90
    buffer_load_dwordx4 a[8:11], v40, s[52:55], s93 offen nt
    s_mul_i32 s93, s89, 20
    s_add_u32 s93, s93, s90
    buffer_load_dwordx4 a[12:15], v40, s[52:55], s93 offen nt
    s_mov_b64 exec, -1
    s_add_u32 s101, s101, 245760
    s_lshl_b32 s86, s3, 11
    s_add_u32 s86, s86, 153600
    v_and_b32 v42, 0x30, v0
    v_lshlrev_b32 v42, 1, v42
    v_xor_b32 v42, v42, v1
    v_add_u32 v42, s86, v42
    v_lshrrev_b32 v140, 2, v0
    v_and_b32 v141, 6, v140
    v_lshlrev_b32 v141, 4, v141
    v_lshl_add_u32 v140, v140, 7, v141
    v_and_b32 v141, 3, v0
    v_lshl_add_u32 v140, v141, 3, v140
    v_add_u32 v140, s86, v140
    v_xor_b32 v141, 32, v140
    v_xor_b32 v142, 64, v140
    v_xor_b32 v143, 96, v140
    v_add_u32 v41, s86, v41
    v_lshl_add_u32 v45, v3, 4, s86
    v_lshl_add_u32 v145, v3, 6, s86
    s_lshl_b32 s86, s3, 8
    s_add_u32 s86, s86, 162304
    v_lshl_add_u32 v144, v3, 4, s86
    v_lshlrev_b32 v146, 4, v2
    v_add_u32 v147, 162304, v146
    s_mov_b32 s40, s28
    s_and_b32 s41, s29, 0xffff
    s_mov_b32 s42, 20185344
    s_mov_b32 s43, 0x20000
    s_waitcnt lgkmcnt(0)
    s_add_u32 s6, s6, 0x9e3779b9
    s_mov_b32 s44, s24
    s_and_b32 s45, s25, 0xffff
    s_mov_b32 s46, 2621440
    s_mov_b32 s47, 0x20000
    v_min_u32 v7, 39, v0
    s_mul_i32 s86, s3, 40
    v_add_lshl_u32 v7, v7, s86, 4
    v_add_u32 v5, 4096, v1
    v_mov_b32 v8, v1
    v_and_b32 v149, 0x70, v1
    v_lshl_add_u32 v152, v3, 7, v149
    v_add_u32 v9, 38400, v8
    v_add_u32 v153, 38400, v152
    v_add_u32 v10, 76800, v8
    v_add_u32 v154, 76800, v152
    v_add_u32 v11, 115200, v8
    v_add_u32 v155, 115200, v152
    v_add_u32 v12, s82, v8
    v_add_u32 v156, s82, v152
    s_lshr_b32 s86, s3, 1
    s_mul_i32 s86, s86, 26112
    s_mul_i32 s87, s3, 6144
    s_add_u32 s86, s86, s87
    s_add_u32 s86, s86, 76800
    v_add_u32 v4, s86, v1
    s_cmp_eq_u32 s3, 1
    s_cselect_b32 s86, 512, 0
    v_or_b32 v157, s86, v1
    s_lshl_b32 s86, s3, 10
    s_add_u32 s86, s86, 76800
    v_add_u32 v157, s86, v157
    s_add_u32 s87, s3, 4
    s_min_u32 s87, s87, 5
    s_lshl_b32 s86, s87, 10
    s_add_u32 s86, s86, 76800
    v_add_u32 v158, s86, v1
    s_lshl_b32 s86, s3, 9
    s_add_u32 s86, s86, 89088
    v_lshl_add_u32 v159, v0, 3, s86
    s_lshl_b32 s86, s87, 9
    s_add_u32 s86, s86, 89088
    v_lshl_add_u32 v160, v0, 3, s86
    s_mul_i32 s86, s3, 3072
    s_add_u32 s86, s86, 89088
    v_lshl_add_u32 v161, v0, 3, s86
    v_and_b32 v148, 1, v3
    v_lshrrev_b32 v149, 1, v3
    v_mad_u32_u24 v162, v148, 3, v149
    v_lshlrev_b32 v150, 4, v2
    v_lshl_add_u32 v162, v162, 8, v150
    v_mul_u32_u24 v149, 20480, v149
    v_lshl_add_u32 v163, v148, 3, v150
    v_add_u32 v163, v163, v149
    s_or_b32 s86, s4, s3
    s_cselect_b32 s86, 0, 0xff61b1e6
    s_mov_b32 s87, 0x80000001
    s_mov_b32 s88, 0x80000000
    s_mov_b32 s89, 0x07070303
    v_mov_b32 v150, 0xff61b1e6
    v_lshlrev_b32 v148, 2, v3
    v_sub_u32 v148, v2, v148
    v_subrev_u32 v149, 0, v148
    v_and_b32 v149, s87, v149
    v_cmp_ne_u32 vcc, 0, v149
    s_nop 1
    v_cndmask_b32 v16, 0, v150, vcc
    v_cmp_ne_u32 vcc, s88, v149
    s_nop 1
    v_cndmask_b32 v20, 0, v150, vcc
    v_or_b32 v24, s86, v20
    v_subrev_u32 v149, 1, v148
    v_and_b32 v149, s87, v149
    v_cmp_ne_u32 vcc, 0, v149
    s_nop 1
    v_cndmask_b32 v17, 0, v150, vcc
    v_cmp_ne_u32 vcc, s88, v149
    s_nop 1
    v_cndmask_b32 v21, 0, v150, vcc
    v_or_b32 v25, s86, v21
    v_subrev_u32 v149, 2, v148
    v_and_b32 v149, s87, v149
    v_cmp_ne_u32 vcc, 0, v149
    s_nop 1
    v_cndmask_b32 v18, 0, v150, vcc
    v_cmp_ne_u32 vcc, s88, v149
    s_nop 1
    v_cndmask_b32 v22, 0, v150, vcc
    v_or_b32 v26, s86, v22
    v_subrev_u32 v149, 3, v148
    v_and_b32 v149, s87, v149
    v_cmp_ne_u32 vcc, 0, v149
    s_nop 1
    v_cndmask_b32 v19, 0, v150, vcc
    v_cmp_ne_u32 vcc, s88, v149
    s_nop 1
    v_cndmask_b32 v23, 0, v150, vcc
    v_or_b32 v27, s86, v23
    v_perm_b32 v28, v21, v20, s89
    v_perm_b32 v29, v23, v22, s89
    v_perm_b32 v30, v17, v16, s89
    v_perm_b32 v31, v19, v18, s89
    s_lshl2_add_u32 s86, s4, s3
    s_mul_i32 s86, s86, 40960
    s_add_u32 s56, s86, 0xe28000
    s_add_u32 s57, s86, 0xe29400
    s_add_u32 s58, s86, 0xe2a800
    s_add_u32 s59, s86, 0xe2bc00
    s_add_u32 s60, s86, 0xe2d000
    s_add_u32 s61, s86, 0xe2e400
    s_add_u32 s62, s86, 0xe2f800
    s_add_u32 s63, s86, 0xe30c00
    s_mul_i32 s87, s5, 1280
    s_add_u32 s65, s86, s87
    s_add_u32 s65, s65, 0x328000
    s_lshl_b32 s86, s4, 3
    s_max_u32 s87, s86, 1
    s_sub_u32 s87, s87, 1
    s_lshl2_add_u32 s88, s87, s3
    s_mul_i32 s88, s88, 5120
    s_add_u32 s64, s88, 0xe28000
    s_lshl1_add_u32 s86, s3, s86
    v_add_u32 v13, s86, v0
    v_mov_b32 v148, s87
    v_cmp_gt_u32 vcc, 2, v0
    s_nop 1
    v_cndmask_b32 v13, v148, v13, vcc
    v_lshlrev_b32 v13, 7, v13
    s_mul_i32 s88, s31, 5120
    s_mul_i32 s89, s3, 204800
    s_add_u32 s66, s88, s89
    s_add_u32 s66, s66, 0x80000
    s_mul_i32 s89, s3, 491520
    s_add_u32 s69, s88, s89
    s_add_u32 s69, s69, 0x148000
    s_mov_b32 s48, s16
    s_and_b32 s49, s17, 0xffff
    s_mov_b32 s50, 1966080
    s_mov_b32 s51, 0x20000
    s_mul_i32 s68, s3, 3072
    s_mul_i32 s89, s5, 192
    s_lshl4_add_u32 s67, s68, s89
    v_add_u32 v148, 0, v0
    v_mul_u32_u24 v149, 171, v148
    v_lshrrev_b32 v149, 11, v149
    v_mul_u32_u24 v150, 12, v149
    v_sub_u32 v148, v148, v150
    v_lshrrev_b32 v150, 2, v149
    v_and_b32 v150, 2, v150
    v_xor_b32 v148, v148, v150
    v_mul_u32_u24 v149, 3072, v149
    v_lshl_add_u32 v164, v148, 4, v149
    v_add_u32 v148, 64, v0
    v_mul_u32_u24 v149, 171, v148
    v_lshrrev_b32 v149, 11, v149
    v_mul_u32_u24 v150, 12, v149
    v_sub_u32 v148, v148, v150
    v_lshrrev_b32 v150, 2, v149
    v_and_b32 v150, 2, v150
    v_xor_b32 v148, v148, v150
    v_mul_u32_u24 v149, 3072, v149
    v_lshl_add_u32 v165, v148, 4, v149
    v_subrev_u32 v165, 1024, v165
    v_add_u32 v148, 128, v0
    v_mul_u32_u24 v149, 171, v148
    v_lshrrev_b32 v149, 11, v149
    v_mul_u32_u24 v150, 12, v149
    v_sub_u32 v148, v148, v150
    v_lshrrev_b32 v150, 2, v149
    v_and_b32 v150, 2, v150
    v_xor_b32 v148, v148, v150
    v_mul_u32_u24 v149, 3072, v149
    v_lshl_add_u32 v166, v148, 4, v149
    v_subrev_u32 v166, 2048, v166
    s_lshl2_add_u32 s26, s83, s3
    s_mul_i32 s26, s26, 5120
    s_add_u32 s26, s26, 0xe28000
    v_mov_b32 v34, 0
    v_mov_b32 v35, 0
    s_lshl_b32 s86, s3, 7
    s_add_u32 s86, s86, 161792
    v_lshl_add_u32 v60, v2, 3, s86
    v_lshlrev_b32 v61, 3, v2
    v_add_u32 v61, 161792, v61
    s_waitcnt vmcnt(5)
    s_add_u32 s87, s100, 1
    s_lshl2_add_u32 s89, s87, s3
    s_mul_i32 s90, s89, 6554
    s_lshr_b32 s90, s90, 16
    s_mul_i32 s88, s90, 10
    s_sub_u32 s89, s89, s88
    s_lshr_b32 s88, s90, 2
    s_mul_i32 s90, s90, 40960
    s_lshl_b32 s75, s89, 12
    s_add_u32 s75, s75, s90
    s_add_u32 s75, s75, 0x80000
    s_lshl_b32 s89, s89, 7
    s_add_u32 s90, s90, s89
    s_sub_u32 s89, s90, 819200
    s_cmp_lt_u32 s87, 170
    s_cselect_b32 s78, -1, 0
    s_cmp_lt_u32 s88, 5
    s_cselect_b32 s52, s12, s18
    s_cselect_b32 s53, s13, s19
    s_cselect_b32 s88, 5, 12
    s_cselect_b32 s90, s90, s89
    s_cmp_gt_u32 s80, 1
    s_cselect_b32 s52, s22, s52
    s_cselect_b32 s53, s23, s53
    s_cselect_b32 s88, 30, s88
    s_cselect_b32 s90, s101, s90
    s_cselect_b32 s89, 6, 1
    s_cselect_b32 s87, -1, s78
    s_cselect_b32 s78, 0, s78
    s_cselect_b64 vcc, -1, 0
    s_and_b32 s53, s53, 0xffff
    s_mul_i32 s54, s88, 163840
    s_mul_i32 s89, s89, 1280
    v_cndmask_b32 v40, v39, v38, vcc
    s_mov_b32 exec_lo, s87
    s_mov_b32 exec_hi, s87
    s_mul_i32 s93, s89, 0
    s_add_u32 s93, s93, s90
    buffer_load_dwordx4 a[16:19], v40, s[52:55], s93 offen nt
    s_mul_i32 s93, s89, 16
    s_add_u32 s93, s93, s90
    buffer_load_dwordx4 a[20:23], v40, s[52:55], s93 offen nt
    s_mul_i32 s93, s89, 4
    s_add_u32 s93, s93, s90
    buffer_load_dwordx4 a[24:27], v40, s[52:55], s93 offen nt
    s_mul_i32 s93, s89, 20
    s_add_u32 s93, s93, s90
    buffer_load_dwordx4 a[28:31], v40, s[52:55], s93 offen nt
    s_mov_b64 exec, -1
    s_add_u32 s101, s101, 245760
    s_add_u32 s87, s100, 2
    s_lshl2_add_u32 s89, s87, s3
    s_mul_i32 s90, s89, 6554
    s_lshr_b32 s90, s90, 16
    s_mul_i32 s88, s90, 10
    s_sub_u32 s89, s89, s88
    s_lshr_b32 s88, s90, 2
    s_mul_i32 s90, s90, 40960
    s_lshl_b32 s76, s89, 12
    s_add_u32 s76, s76, s90
    s_add_u32 s76, s76, 0x80000
    s_lshl_b32 s89, s89, 7
    s_add_u32 s90, s90, s89
    s_sub_u32 s89, s90, 819200
    s_cmp_lt_u32 s87, 170
    s_cselect_b32 s79, -1, 0
    s_cmp_lt_u32 s88, 5
    s_cselect_b32 s52, s12, s18
    s_cselect_b32 s53, s13, s19
    s_cselect_b32 s88, 5, 12
    s_cselect_b32 s90, s90, s89
    s_cmp_gt_u32 s80, 2
    s_cselect_b32 s52, s22, s52
    s_cselect_b32 s53, s23, s53
    s_cselect_b32 s88, 30, s88
    s_cselect_b32 s90, s101, s90
    s_cselect_b32 s89, 6, 1
    s_cselect_b32 s87, -1, s79
    s_cselect_b32 s79, 0, s79
    s_cselect_b64 vcc, -1, 0
    s_and_b32 s53, s53, 0xffff
    s_mul_i32 s54, s88, 163840
    s_mul_i32 s89, s89, 1280
    v_cndmask_b32 v40, v39, v38, vcc
    s_mov_b32 exec_lo, s87
    s_mov_b32 exec_hi, s87
    s_mul_i32 s93, s89, 0
    s_add_u32 s93, s93, s90
    buffer_load_dwordx4 a[32:35], v40, s[52:55], s93 offen nt
    s_mul_i32 s93, s89, 16
    s_add_u32 s93, s93, s90
    buffer_load_dwordx4 a[36:39], v40, s[52:55], s93 offen nt
    s_mul_i32 s93, s89, 4
    s_add_u32 s93, s93, s90
    buffer_load_dwordx4 a[40:43], v40, s[52:55], s93 offen nt
    s_mul_i32 s93, s89, 20
    s_add_u32 s93, s93, s90
    buffer_load_dwordx4 a[44:47], v40, s[52:55], s93 offen nt
    s_mov_b64 exec, -1
    s_add_u32 s101, s101, 245760
    v_dot2c_f32_bf16 v34, s95, v76
    v_dot2c_f32_bf16 v35, v76, v76
    v_dot2c_f32_bf16 v34, s95, v77
    v_dot2c_f32_bf16 v35, v77, v77
    v_dot2c_f32_bf16 v34, s95, v78
    v_dot2c_f32_bf16 v35, v78, v78
    v_dot2c_f32_bf16 v34, s95, v79
    v_dot2c_f32_bf16 v35, v79, v79
    v_dot2c_f32_bf16 v34, s95, v80
    v_dot2c_f32_bf16 v35, v80, v80
    v_dot2c_f32_bf16 v34, s95, v81
    v_dot2c_f32_bf16 v35, v81, v81
    v_dot2c_f32_bf16 v34, s95, v82
    v_dot2c_f32_bf16 v35, v82, v82
    v_dot2c_f32_bf16 v34, s95, v83
    v_dot2c_f32_bf16 v35, v83, v83
    v_dot2c_f32_bf16 v34, s95, v84
    v_dot2c_f32_bf16 v35, v84, v84
    v_dot2c_f32_bf16 v34, s95, v85
    v_dot2c_f32_bf16 v35, v85, v85
    v_dot2c_f32_bf16 v34, s95, v86
    v_dot2c_f32_bf16 v35, v86, v86
    v_dot2c_f32_bf16 v34, s95, v87
    v_dot2c_f32_bf16 v35, v87, v87
    v_dot2c_f32_bf16 v34, s95, v88
    v_dot2c_f32_bf16 v35, v88, v88
    v_dot2c_f32_bf16 v34, s95, v89
    v_dot2c_f32_bf16 v35, v89, v89
    v_dot2c_f32_bf16 v34, s95, v90
    v_dot2c_f32_bf16 v35, v90, v90
    v_dot2c_f32_bf16 v34, s95, v91
    v_dot2c_f32_bf16 v35, v91, v91
    v_dot2c_f32_bf16 v34, s95, v92
    v_dot2c_f32_bf16 v35, v92, v92
    v_dot2c_f32_bf16 v34, s95, v93
    v_dot2c_f32_bf16 v35, v93, v93
    v_dot2c_f32_bf16 v34, s95, v94
    v_dot2c_f32_bf16 v35, v94, v94
    v_dot2c_f32_bf16 v34, s95, v95
    v_dot2c_f32_bf16 v35, v95, v95
    s_nop 1
    v_mov_b32 v36, v34
    v_mov_b32 v37, v35
    s_nop 0
    v_permlane32_swap_b32 v34, v36
    v_permlane32_swap_b32 v35, v37
    v_add_f32 v34, v34, v36
    v_add_f32 v35, v35, v37
    v_mov_b32 v36, v34
    v_mov_b32 v37, v35
    s_nop 0
    v_permlane16_swap_b32 v34, v36
    v_permlane16_swap_b32 v35, v37
    v_add_f32 v34, v34, v36
    v_add_f32 v35, v35, v37
    ds_write_b64 v60, v[34:35]
    s_waitcnt lgkmcnt(0)
    s_barrier
    ds_read_b64 v[62:63], v61 offset:0
    ds_read_b64 v[64:65], v61 offset:128
    ds_read_b64 v[66:67], v61 offset:256
    ds_read_b64 v[68:69], v61 offset:384
    v_lshlrev_b32 v176, 16, v76
    v_and_b32 v177, s96, v76
    v_lshlrev_b32 v178, 16, v77
    v_and_b32 v179, s96, v77
    v_lshlrev_b32 v180, 16, v78
    v_and_b32 v181, s96, v78
    v_lshlrev_b32 v182, 16, v79
    v_and_b32 v183, s96, v79
    v_lshlrev_b32 v184, 16, v80
    v_and_b32 v185, s96, v80
    v_lshlrev_b32 v186, 16, v81
    v_and_b32 v187, s96, v81
    v_lshlrev_b32 v188, 16, v82
    v_and_b32 v189, s96, v82
    v_lshlrev_b32 v190, 16, v83
    v_and_b32 v191, s96, v83
    v_lshlrev_b32 v192, 16, v84
    v_and_b32 v193, s96, v84
    v_lshlrev_b32 v194, 16, v85
    v_and_b32 v195, s96, v85
    v_lshlrev_b32 v196, 16, v86
    v_and_b32 v197, s96, v86
    v_lshlrev_b32 v198, 16, v87
    v_and_b32 v199, s96, v87
    v_lshlrev_b32 v200, 16, v88
    v_and_b32 v201, s96, v88
    v_lshlrev_b32 v202, 16, v89
    v_and_b32 v203, s96, v89
    v_lshlrev_b32 v204, 16, v90
    v_and_b32 v205, s96, v90
    v_lshlrev_b32 v206, 16, v91
    v_and_b32 v207, s96, v91
    v_lshlrev_b32 v208, 16, v92
    v_and_b32 v209, s96, v92
    v_lshlrev_b32 v210, 16, v93
    v_and_b32 v211, s96, v93
    v_lshlrev_b32 v212, 16, v94
    v_and_b32 v213, s96, v94
    v_lshlrev_b32 v214, 16, v95
    v_and_b32 v215, s96, v95
    s_waitcnt lgkmcnt(0)
    v_pk_add_f32 v[62:63], v[62:63], v[64:65]
    v_pk_add_f32 v[66:67], v[66:67], v[68:69]
    v_pk_add_f32 v[34:35], v[62:63], v[66:67]
    s_mov_b32 s93, 0x3acccccd
    v_mul_f32 v34, 0x3acccccd, v34
    v_mul_f32 v36, v34, v34
    v_fma_f32 v35, v35, s93, -v36
    v_max_f32 v35, 0, v35
    v_add_f32 v35, 0x3727c5ac, v35
    v_rsq_f32 v35, v35
    s_nop 0
    v_mul_f32 v34, -v34, v35
    v_pk_fma_f32 v[176:177], v[176:177], v[34:35], v[34:35] op_sel:[0,1,0] op_sel_hi:[1,1,0]
    v_pk_fma_f32 v[178:179], v[178:179], v[34:35], v[34:35] op_sel:[0,1,0] op_sel_hi:[1,1,0]
    v_pk_fma_f32 v[180:181], v[180:181], v[34:35], v[34:35] op_sel:[0,1,0] op_sel_hi:[1,1,0]
    v_pk_fma_f32 v[182:183], v[182:183], v[34:35], v[34:35] op_sel:[0,1,0] op_sel_hi:[1,1,0]
    v_cvt_pk_f16_f32 v76, v176, v178
    v_cvt_pk_f16_f32 v77, v180, v182
    v_cvt_pk_f16_f32 v78, v177, v179
    v_cvt_pk_f16_f32 v79, v181, v183
    buffer_store_dwordx4 v[76:79], v1, s[40:43], s26 offen offset:0 sc1
    v_pk_fma_f32 v[184:185], v[184:185], v[34:35], v[34:35] op_sel:[0,1,0] op_sel_hi:[1,1,0]
    v_pk_fma_f32 v[186:187], v[186:187], v[34:35], v[34:35] op_sel:[0,1,0] op_sel_hi:[1,1,0]
    v_pk_fma_f32 v[188:189], v[188:189], v[34:35], v[34:35] op_sel:[0,1,0] op_sel_hi:[1,1,0]
    v_pk_fma_f32 v[190:191], v[190:191], v[34:35], v[34:35] op_sel:[0,1,0] op_sel_hi:[1,1,0]
    v_cvt_pk_f16_f32 v80, v184, v186
    v_cvt_pk_f16_f32 v81, v188, v190
    v_cvt_pk_f16_f32 v82, v185, v187
    v_cvt_pk_f16_f32 v83, v189, v191
    buffer_store_dwordx4 v[80:83], v1, s[40:43], s26 offen offset:1024 sc1
    v_pk_fma_f32 v[192:193], v[192:193], v[34:35], v[34:35] op_sel:[0,1,0] op_sel_hi:[1,1,0]
    v_pk_fma_f32 v[194:195], v[194:195], v[34:35], v[34:35] op_sel:[0,1,0] op_sel_hi:[1,1,0]
    v_pk_fma_f32 v[196:197], v[196:197], v[34:35], v[34:35] op_sel:[0,1,0] op_sel_hi:[1,1,0]
    v_pk_fma_f32 v[198:199], v[198:199], v[34:35], v[34:35] op_sel:[0,1,0] op_sel_hi:[1,1,0]
    v_cvt_pk_f16_f32 v84, v192, v194
    v_cvt_pk_f16_f32 v85, v196, v198
    v_cvt_pk_f16_f32 v86, v193, v195
    v_cvt_pk_f16_f32 v87, v197, v199
    buffer_store_dwordx4 v[84:87], v1, s[40:43], s26 offen offset:2048 sc1
    v_pk_fma_f32 v[200:201], v[200:201], v[34:35], v[34:35] op_sel:[0,1,0] op_sel_hi:[1,1,0]
    v_pk_fma_f32 v[202:203], v[202:203], v[34:35], v[34:35] op_sel:[0,1,0] op_sel_hi:[1,1,0]
    v_pk_fma_f32 v[204:205], v[204:205], v[34:35], v[34:35] op_sel:[0,1,0] op_sel_hi:[1,1,0]
    v_pk_fma_f32 v[206:207], v[206:207], v[34:35], v[34:35] op_sel:[0,1,0] op_sel_hi:[1,1,0]
    v_cvt_pk_f16_f32 v88, v200, v202
    v_cvt_pk_f16_f32 v89, v204, v206
    v_cvt_pk_f16_f32 v90, v201, v203
    v_cvt_pk_f16_f32 v91, v205, v207
    buffer_store_dwordx4 v[88:91], v1, s[40:43], s26 offen offset:3072 sc1
    v_pk_fma_f32 v[208:209], v[208:209], v[34:35], v[34:35] op_sel:[0,1,0] op_sel_hi:[1,1,0]
    v_pk_fma_f32 v[210:211], v[210:211], v[34:35], v[34:35] op_sel:[0,1,0] op_sel_hi:[1,1,0]
    v_pk_fma_f32 v[212:213], v[212:213], v[34:35], v[34:35] op_sel:[0,1,0] op_sel_hi:[1,1,0]
    v_pk_fma_f32 v[214:215], v[214:215], v[34:35], v[34:35] op_sel:[0,1,0] op_sel_hi:[1,1,0]
    v_cvt_pk_f16_f32 v92, v208, v210
    v_cvt_pk_f16_f32 v93, v212, v214
    v_cvt_pk_f16_f32 v94, v209, v211
    v_cvt_pk_f16_f32 v95, v213, v215
    buffer_store_dwordx4 v[92:95], v5, s[40:43], s26 offen offset:0 sc1
    s_lshl_b32 s86, s83, 7
    s_add_u32 s86, s86, 0x1a000
    s_waitcnt vmcnt(17)
    v_lshlrev_b32 v46, 16, v52
    v_and_b32 v47, s96, v52
    v_mul_f32 v48, 0xbfb8aa3b, v46
    v_mul_f32 v49, 0xbfb8aa3b, v47
    v_exp_f32 v48, v48
    v_exp_f32 v49, v49
    v_add_f32 v48, 1.0, v48
    v_add_f32 v49, 1.0, v49
    v_rcp_f32 v48, v48
    v_rcp_f32 v49, v49
    v_mul_f32 v46, v46, v48
    v_mul_f32 v47, v47, v49
    v_cvt_pk_bf16_f32 v44, v46, v47
    ds_write_b32 v41, v44
    ds_read_b128 v[128:131], v45 offset:0
    ds_read_b128 v[132:135], v45 offset:64
    ds_read_b128 v[136:139], v45 offset:128
    s_waitcnt vmcnt(13)
    ds_write_b128 v42, a[0:3] offset:0
    ds_write_b128 v42, a[4:7] offset:1024
    ds_read_b64_tr_b16 v[96:97], v140
    ds_read_b64_tr_b16 v[100:101], v141
    ds_read_b64_tr_b16 v[104:105], v142
    ds_read_b64_tr_b16 v[108:109], v143
    ds_write_b128 v42, a[8:11] offset:0
    ds_write_b128 v42, a[12:15] offset:1024
    ds_read_b64_tr_b16 v[98:99], v140
    ds_read_b64_tr_b16 v[102:103], v141
    ds_read_b64_tr_b16 v[106:107], v142
    ds_read_b64_tr_b16 v[110:111], v143
    s_waitcnt vmcnt(9)
    ds_write_b128 v42, a[16:19] offset:0
    ds_write_b128 v42, a[20:23] offset:1024
    ds_read_b64_tr_b16 v[112:113], v140
    ds_read_b64_tr_b16 v[116:117], v141
    ds_read_b64_tr_b16 v[120:121], v142
    ds_read_b64_tr_b16 v[124:125], v143
    ds_write_b128 v42, a[24:27] offset:0
    ds_write_b128 v42, a[28:31] offset:1024
    ds_read_b64_tr_b16 v[114:115], v140
    ds_read_b64_tr_b16 v[118:119], v141
    ds_read_b64_tr_b16 v[122:123], v142
    ds_read_b64_tr_b16 v[126:127], v143
    s_waitcnt vmcnt(5)
    ds_write_b128 v42, a[32:35] offset:0
    ds_write_b128 v42, a[36:39] offset:1024
    ds_read_b64_tr_b16 v[176:177], v140
    ds_read_b64_tr_b16 v[180:181], v141
    ds_read_b64_tr_b16 v[184:185], v142
    ds_read_b64_tr_b16 v[188:189], v143
    ds_write_b128 v42, a[40:43] offset:0
    ds_write_b128 v42, a[44:47] offset:1024
    ds_read_b64_tr_b16 v[178:179], v140
    ds_read_b64_tr_b16 v[182:183], v141
    ds_read_b64_tr_b16 v[186:187], v142
    ds_read_b64_tr_b16 v[190:191], v143
    s_waitcnt vmcnt(0)
    s_waitcnt lgkmcnt(0)
    s_barrier
    s_cmp_lg_u32 s3, 0
    s_cbranch_scc1 pub_12
    v_mov_b32 v14, s6
    s_mov_b32 exec_lo, 1
    s_mov_b32 exec_hi, 0
    buffer_store_dword v14, off, s[40:43], s86 sc1
    s_mov_b64 exec, -1
pub_12:
    s_mov_b32 s97, 0
    s_mov_b64 s[70:71], 0xffff
    s_mov_b32 s72, 0xffff0000
    s_mov_b32 s73, 0
    s_lshl_b32 s92, s5, 12
    s_mul_i32 s86, s3, 640
    s_add_u32 s92, s92, s86
    s_add_u32 s92, s92, 0x60000
    v_and_b32 v50, 7, v0
    v_min_u32 v50, 4, v50
    v_lshlrev_b32 v50, 7, v50
    v_add_u32 v50, s92, v50
    v_add_u32 v13, 0x1a000, v13
    v_cmp_gt_u32 vcc, 32, v0
    s_nop 1
    v_cndmask_b32 v50, v50, v13, vcc
    s_mov_b32 s94, 0x8000
    s_mov_b32 s86, 0x24000
    buffer_load_dwordx4 v[52:55], v7, s[40:43], s86 offen sc1
    s_mov_b32 s86, 0x27c00
    buffer_load_dwordx4 v[56:59], v7, s[40:43], s86 offen sc1
    s_mov_b32 s86, 0x2b800
    buffer_load_dwordx4 v[60:63], v7, s[40:43], s86 offen sc1
    s_mov_b32 s86, 0x2f400
    buffer_load_dwordx4 v[64:67], v7, s[40:43], s86 offen sc1
    s_mov_b32 s86, 0x33000
    buffer_load_dwordx4 v[68:71], v7, s[40:43], s86 offen sc1
    s_mov_b32 s86, 0x24a00
    buffer_load_dwordx4 v[72:75], v7, s[40:43], s86 offen sc1
    s_mov_b32 s86, 0x28600
    buffer_load_dwordx4 v[76:79], v7, s[40:43], s86 offen sc1
    s_mov_b32 s86, 0x2c200
    buffer_load_dwordx4 v[80:83], v7, s[40:43], s86 offen sc1
    s_mov_b32 s86, 0x2fe00
    buffer_load_dwordx4 v[84:87], v7, s[40:43], s86 offen sc1
    s_mov_b32 s86, 0x33a00
    buffer_load_dwordx4 v[88:91], v7, s[40:43], s86 offen sc1
    buffer_load_dword v51, v50, s[40:43], 0 offen sc1
    v_mfma_f32_16x16x32_bf16 v[204:207], v[96:99], v[128:131], 0
    v_mfma_f32_16x16x32_bf16 v[208:211], v[100:103], v[128:131], 0
    v_mfma_f32_16x16x32_bf16 v[212:215], v[104:107], v[128:131], 0
    v_mfma_f32_16x16x32_bf16 v[216:219], v[108:111], v[128:131], 0
    v_mfma_f32_16x16x32_bf16 v[204:207], v[112:115], v[132:135], v[204:207]
    v_mfma_f32_16x16x32_bf16 v[208:211], v[116:119], v[132:135], v[208:211]
    v_mfma_f32_16x16x32_bf16 v[212:215], v[120:123], v[132:135], v[212:215]
    v_mfma_f32_16x16x32_bf16 v[216:219], v[124:127], v[132:135], v[216:219]
    s_cmp_lg_u32 s80, 3
    s_cbranch_scc1 nomf_15
    v_mfma_f32_16x16x32_bf16 v[204:207], v[176:179], v[136:139], v[204:207]
    v_mfma_f32_16x16x32_bf16 v[208:211], v[180:183], v[136:139], v[208:211]
    v_mfma_f32_16x16x32_bf16 v[212:215], v[184:187], v[136:139], v[212:215]
    v_mfma_f32_16x16x32_bf16 v[216:219], v[188:191], v[136:139], v[216:219]
nomf_15:
    s_mov_b32 exec_lo, 0x00010001
    s_mov_b32 exec_hi, 0x00010001
    s_nop 6
    ds_write_b128 v144, v[204:207] offset:0
    ds_write_b128 v144, v[208:211] offset:64
    ds_write_b128 v144, v[212:215] offset:128
    ds_write_b128 v144, v[216:219] offset:192
    s_mov_b64 exec, -1
    s_mul_i32 s86, s3, 1408
    s_add_u32 s86, s86, 153600
    v_and_b32 v33, 16, v7
    v_sub_u32 v34, v7, v33
    v_lshrrev_b32 v33, 2, v33
    v_add3_u32 v33, v33, v34, s86
    v_lshlrev_b32 v167, 5, v3
    v_add_u32 v167, 153600, v167
    s_lshl_b32 s86, s3, 11
    v_add_u32 v6, s86, v167
    s_mov_b32 s91, 0
    s_waitcnt vmcnt(0)
cfp_13:
    v_cmp_ne_u32 vcc, s6, v51
    s_cmp_eq_u32 vcc_hi, 0
    s_cbranch_scc1 cfd_14
    buffer_load_dword v51, v50, s[40:43], 0 offen sc1
    s_sub_u32 s94, s94, 1
    s_cmp_lg_u32 s94, 0
    s_waitcnt vmcnt(0)
    s_cbranch_scc1 cfp_13
cfd_14:
    s_add_u32 m0, s82, 0
    s_add_u32 s93, s84, 0
    buffer_load_dwordx4 v1, s[40:43], s93 offen offset:0 sc1 lds
    buffer_load_dwordx4 v1, s[40:43], s93 offen offset:1024 sc1 lds
    buffer_load_dwordx4 v1, s[40:43], s93 offen offset:2048 sc1 lds
    buffer_load_dwordx4 v1, s[40:43], s93 offen offset:3072 sc1 lds
    s_add_u32 m0, s82, 4096
    s_add_u32 s93, s84, 4096
    buffer_load_dwordx4 v1, s[40:43], s93 offen offset:0 sc1 lds
    buffer_load_dwordx4 v1, s[40:43], s93 offen offset:1024 sc1 lds
    buffer_load_dwordx4 v1, s[40:43], s93 offen offset:2048 sc1 lds
    buffer_load_dwordx4 v1, s[40:43], s93 offen offset:3072 sc1 lds
    s_cmp_eq_u32 vcc_lo, 0
    s_cbranch_scc1 fxok_16
    s_mov_b32 s94, 0x8000
poll_17:
    buffer_load_dword v32, v13, s[40:43], s91 offen sc1
    s_waitcnt vmcnt(0)
    v_cmp_ne_u32 vcc, s6, v32
    s_cbranch_vccz pdone_18
    s_sub_u32 s94, s94, 1
    s_cmp_lg_u32 s94, 0
    s_cbranch_scc1 poll_17
pdone_18:
fxok_16:
    buffer_load_dwordx4 v[220:223], v1, s[40:43], s56 offen offset:0 sc1
    buffer_load_dwordx4 v[224:227], v1, s[40:43], s60 offen offset:0 sc1
    buffer_load_dwordx4 v[200:203], v1, s[40:43], s64 offen offset:0 sc1
    buffer_load_dwordx4 v[228:231], v1, s[40:43], s57 offen offset:0 sc1
    buffer_load_dwordx4 v[232:235], v1, s[40:43], s61 offen offset:0 sc1
    s_mov_b32 s94, 0x8000
    s_bfe_u32 s87, s6, 0x80000
    s_bfe_u32 s88, s6, 0x80008
    s_bfe_u32 s89, s6, 0x80010
    s_bfe_u32 s90, s6, 0x80018
mchk_19:
    v_xor_b32 v52, s87, v52
    v_xor_b32 v53, s88, v53
    v_or_b32 v36, v52, v53
    v_xor_b32 v54, s89, v54
    v_xor_b32 v55, s90, v55
    v_or3_b32 v36, v36, v54, v55
    v_xor_b32 v56, s87, v56
    v_xor_b32 v57, s88, v57
    v_or3_b32 v36, v36, v56, v57
    v_xor_b32 v58, s89, v58
    v_xor_b32 v59, s90, v59
    v_or3_b32 v36, v36, v58, v59
    v_xor_b32 v60, s87, v60
    v_xor_b32 v61, s88, v61
    v_or3_b32 v36, v36, v60, v61
    v_xor_b32 v62, s89, v62
    v_xor_b32 v63, s90, v63
    v_or3_b32 v36, v36, v62, v63
    v_xor_b32 v64, s87, v64
    v_xor_b32 v65, s88, v65
    v_or3_b32 v36, v36, v64, v65
    v_xor_b32 v66, s89, v66
    v_xor_b32 v67, s90, v67
    v_or3_b32 v36, v36, v66, v67
    v_xor_b32 v68, s87, v68
    v_xor_b32 v69, s88, v69
    v_or3_b32 v36, v36, v68, v69
    v_xor_b32 v70, s89, v70
    v_xor_b32 v71, s90, v71
    v_or3_b32 v36, v36, v70, v71
    v_xor_b32 v72, s87, v72
    v_xor_b32 v73, s88, v73
    v_or3_b32 v36, v36, v72, v73
    v_xor_b32 v74, s89, v74
    v_xor_b32 v75, s90, v75
    v_or3_b32 v36, v36, v74, v75
    v_xor_b32 v76, s87, v76
    v_xor_b32 v77, s88, v77
    v_or3_b32 v36, v36, v76, v77
    v_xor_b32 v78, s89, v78
    v_xor_b32 v79, s90, v79
    v_or3_b32 v36, v36, v78, v79
    v_xor_b32 v80, s87, v80
    v_xor_b32 v81, s88, v81
    v_or3_b32 v36, v36, v80, v81
    v_xor_b32 v82, s89, v82
    v_xor_b32 v83, s90, v83
    v_or3_b32 v36, v36, v82, v83
    v_xor_b32 v84, s87, v84
    v_xor_b32 v85, s88, v85
    v_or3_b32 v36, v36, v84, v85
    v_xor_b32 v86, s89, v86
    v_xor_b32 v87, s90, v87
    v_or3_b32 v36, v36, v86, v87
    v_xor_b32 v88, s87, v88
    v_xor_b32 v89, s88, v89
    v_or3_b32 v36, v36, v88, v89
    v_xor_b32 v90, s89, v90
    v_xor_b32 v91, s90, v91
    v_or3_b32 v36, v36, v90, v91
    v_cmp_ne_u32_sdwa vcc, v36, v0 src0_sel:BYTE_0 src1_sel:BYTE_3
    s_cbranch_vccnz mcold_20
mok_21:
    v_pk_add_f32 v[52:53], v[52:53], v[56:57]
    v_pk_add_f32 v[54:55], v[54:55], v[58:59]
    v_pk_add_f32 v[72:73], v[72:73], v[76:77]
    v_pk_add_f32 v[74:75], v[74:75], v[78:79]
    v_pk_add_f32 v[52:53], v[52:53], v[60:61]
    v_pk_add_f32 v[54:55], v[54:55], v[62:63]
    v_pk_add_f32 v[72:73], v[72:73], v[80:81]
    v_pk_add_f32 v[74:75], v[74:75], v[82:83]
    v_pk_add_f32 v[52:53], v[52:53], v[64:65]
    v_pk_add_f32 v[54:55], v[54:55], v[66:67]
    v_pk_add_f32 v[72:73], v[72:73], v[84:85]
    v_pk_add_f32 v[74:75], v[74:75], v[86:87]
    v_pk_add_f32 v[52:53], v[52:53], v[68:69]
    v_pk_add_f32 v[54:55], v[54:55], v[70:71]
    v_pk_add_f32 v[72:73], v[72:73], v[88:89]
    v_pk_add_f32 v[74:75], v[74:75], v[90:91]
    v_cvt_pk_bf16_f32 v52, v52, v53
    v_cvt_pk_bf16_f32 v53, v54, v55
    v_cvt_pk_bf16_f32 v72, v72, v73
    v_cvt_pk_bf16_f32 v73, v74, v75
    v_lshlrev_b32 v76, 16, v72
    v_and_b32 v77, s96, v72
    v_lshlrev_b32 v78, 16, v73
    v_and_b32 v79, s96, v73
    v_add_f32 v76, 1.0, v76
    v_add_f32 v77, 1.0, v77
    v_add_f32 v78, 1.0, v78
    v_add_f32 v79, 1.0, v79
    v_cvt_pk_bf16_f32 v72, v76, v77
    v_cvt_pk_bf16_f32 v73, v78, v79
    v_lshlrev_b32 v40, 16, v52
    v_and_b32 v41, s96, v52
    v_lshlrev_b32 v42, 16, v53
    v_and_b32 v43, s96, v53
    v_lshlrev_b32 v44, 16, v72
    v_and_b32 v45, s96, v72
    v_lshlrev_b32 v46, 16, v73
    v_and_b32 v47, s96, v73
    v_cvt_pk_f16_f32 v36, v44, v46
    v_cvt_pk_f16_f32 v37, v45, v47
    v_cvt_pk_f16_f32 v38, v40, v42
    v_cvt_pk_f16_f32 v39, v41, v43
    ds_write2_b32 v33, v36, v37 offset0:0 offset1:2
    ds_write2_b32 v33, v38, v39 offset0:4 offset1:6
    buffer_load_dwordx4 v[236:239], v1, s[40:43], s58 offen offset:0 sc1
    s_add_u32 m0, s82, 8192
    s_add_u32 s93, s84, 8192
    buffer_load_dwordx4 v1, s[40:43], s93 offen offset:0 sc1 lds
    buffer_load_dwordx4 v[240:243], v1, s[40:43], s62 offen offset:0 sc1
    buffer_load_dwordx4 v1, s[40:43], s93 offen offset:1024 sc1 lds
    buffer_load_dwordx4 v[244:247], v1, s[40:43], s59 offen offset:0 sc1
    buffer_load_dwordx4 v1, s[40:43], s93 offen offset:2048 sc1 lds
    buffer_load_dwordx4 v[248:251], v1, s[40:43], s63 offen offset:0 sc1
    buffer_load_dwordx4 v1, s[40:43], s93 offen offset:3072 sc1 lds
    s_add_u32 m0, s82, 12288
    s_add_u32 s93, s84, 12288
    buffer_load_dwordx4 v1, s[40:43], s93 offen offset:0 sc1 lds
    buffer_load_dwordx4 v1, s[40:43], s93 offen offset:1024 sc1 lds
    s_waitcnt lgkmcnt(0)
    s_barrier
    s_cmp_eq_u32 s80, 0
    s_cselect_b32 s91, 1, s3
    s_cmp_lg_u32 s91, 0
    s_cselect_b32 s91, 0, 0xffff
    s_cbranch_scc1 nomod_22
    ds_read_b128 v[204:207], v147 offset:0
    ds_read_b128 v[208:211], v147 offset:256
    ds_read_b128 v[212:215], v147 offset:512
    ds_read_b128 v[216:219], v147 offset:768
    s_mov_b32 s86, 0xffffff00
    s_bfe_u32 s87, s6, 0x80000
    s_bfe_u32 s88, s6, 0x80008
    s_bfe_u32 s89, s6, 0x80010
    s_bfe_u32 s90, s6, 0x80018
    s_waitcnt lgkmcnt(0)
    v_pk_add_f32 v[204:205], v[204:205], v[208:209]
    v_pk_add_f32 v[212:213], v[212:213], v[216:217]
    v_pk_add_f32 v[206:207], v[206:207], v[210:211]
    v_pk_add_f32 v[214:215], v[214:215], v[218:219]
    v_pk_add_f32 v[204:205], v[204:205], v[212:213]
    v_pk_add_f32 v[206:207], v[206:207], v[214:215]
    v_and_b32 v204, s86, v204
    v_and_b32 v205, s86, v205
    v_and_b32 v206, s86, v206
    v_and_b32 v207, s86, v207
    v_or_b32 v204, s87, v204
    v_or_b32 v205, s88, v205
    v_or_b32 v206, s89, v206
    v_or_b32 v207, s90, v207
nomod_22:
    s_mov_b32 exec_lo, s91
    s_mov_b32 exec_hi, 0
    buffer_store_dwordx4 v[204:207], v146, s[40:43], s81 offen sc1
    s_mov_b64 exec, -1
    s_mov_b32 exec_lo, s77
    s_mov_b32 exec_hi, s77
    buffer_store_dwordx4 v[96:99], v1, s[40:43], s74 offen offset:0 sc1
    buffer_store_dwordx4 v[100:103], v1, s[40:43], s74 offen offset:1024 sc1
    buffer_store_dwordx4 v[104:107], v1, s[40:43], s74 offen offset:2048 sc1
    buffer_store_dwordx4 v[108:111], v1, s[40:43], s74 offen offset:3072 sc1
    s_mov_b64 exec, -1
    s_mov_b32 exec_lo, s78
    s_mov_b32 exec_hi, s78
    buffer_store_dwordx4 v[112:115], v1, s[40:43], s75 offen offset:0 sc1
    buffer_store_dwordx4 v[116:119], v1, s[40:43], s75 offen offset:1024 sc1
    buffer_store_dwordx4 v[120:123], v1, s[40:43], s75 offen offset:2048 sc1
    buffer_store_dwordx4 v[124:127], v1, s[40:43], s75 offen offset:3072 sc1
    s_mov_b64 exec, -1
    s_mov_b32 exec_lo, s79
    s_mov_b32 exec_hi, s79
    buffer_store_dwordx4 v[176:179], v1, s[40:43], s76 offen offset:0 sc1
    buffer_store_dwordx4 v[180:183], v1, s[40:43], s76 offen offset:1024 sc1
    buffer_store_dwordx4 v[184:187], v1, s[40:43], s76 offen offset:2048 sc1
    buffer_store_dwordx4 v[188:191], v1, s[40:43], s76 offen offset:3072 sc1
    s_mov_b64 exec, -1
    buffer_load_dwordx4 v1, s[40:43], s93 offen offset:2048 sc1 lds
    s_waitcnt vmcnt(26)
    s_waitcnt lgkmcnt(0)
join_2:
    s_and_b32 s100, s7, 31
    s_lshl2_add_u32 s100, s100, s3
    s_barrier
    ds_read_b128 v[168:171], v167 offset:0
    ds_read_b128 v[172:175], v167 offset:16
    ds_read_b128 v[40:43], v6 offset:0
    ds_read_b128 v[44:47], v6 offset:16
    ds_read_b128 v[120:123], v8 offset:0
    ds_read_b128 v[124:127], v8 offset:1024
    ds_read_b128 v[128:131], v8 offset:2048
    ds_read_b128 v[132:135], v8 offset:3072
    ds_read_b128 v[136:139], v8 offset:4096
    ds_read_b128 v[140:143], v8 offset:5120
    ds_read_b128 v[144:147], v8 offset:6144
    ds_read_b128 v[148:151], v152 offset:7168
    s_waitcnt lgkmcnt(8)
    v_pk_fma_f16 v220, v220, v168, v172
    v_pk_fma_f16 v221, v221, v169, v173
    v_pk_fma_f16 v222, v222, v170, v174
    v_pk_fma_f16 v223, v223, v171, v175
    v_pk_fma_f16 v224, v224, v168, v172
    v_pk_fma_f16 v225, v225, v169, v173
    v_pk_fma_f16 v226, v226, v170, v174
    v_pk_fma_f16 v227, v227, v171, v175
    v_pk_fma_f16 v200, v200, v40, v44
    v_pk_fma_f16 v201, v201, v41, v45
    v_pk_fma_f16 v202, v202, v42, v46
    v_pk_fma_f16 v203, v203, v43, v47
    s_waitcnt lgkmcnt(4)
    v_mfma_f32_16x16x32_f16 v[32:35], v[120:123], v[220:223], 0
    v_mfma_f32_16x16x32_f16 v[64:67], v[120:123], v[224:227], 0
    ds_read_b128 v[168:171], v167 offset:2048
    s_add_u32 m0, s82, 12288
    s_add_u32 s93, s84, 12288
    buffer_load_dwordx4 v1, s[40:43], s93 offen offset:3072 sc1 lds
    v_mfma_f32_16x16x32_f16 v[36:39], v[124:127], v[220:223], 0
    ds_read_b128 v[120:123], v9 offset:0
    v_mfma_f32_16x16x32_f16 v[68:71], v[124:127], v[224:227], 0
    ds_read_b128 v[172:175], v167 offset:2064
    v_mfma_f32_16x16x32_f16 v[40:43], v[128:131], v[220:223], 0
    ds_read_b128 v[124:127], v9 offset:1024
    buffer_load_dwordx4 a[0:3], v1, s[40:43], s56 offen offset:1024 sc1
    v_mfma_f32_16x16x32_f16 v[72:75], v[128:131], v[224:227], 0
    v_mfma_f32_16x16x32_f16 v[44:47], v[132:135], v[220:223], 0
    ds_read_b128 v[128:131], v9 offset:2048
    v_mfma_f32_16x16x32_f16 v[76:79], v[132:135], v[224:227], 0
    s_waitcnt vmcnt(26)
    s_waitcnt lgkmcnt(5)
    v_mfma_f32_16x16x32_f16 v[48:51], v[136:139], v[220:223], 0
    ds_read_b128 v[132:135], v9 offset:3072
    s_add_u32 m0, s82, 16384
    s_add_u32 s93, s84, 16384
    buffer_load_dwordx4 v1, s[40:43], s93 offen offset:0 sc1 lds
    v_mfma_f32_16x16x32_f16 v[80:83], v[136:139], v[224:227], 0
    s_waitcnt lgkmcnt(3)
    v_pk_fma_f16 v228, v228, v168, v172
    v_pk_fma_f16 v229, v229, v169, v173
    v_mfma_f32_16x16x32_f16 v[52:55], v[220:223], v[140:143], 0
    ds_read_b128 v[136:139], v9 offset:4096
    v_pk_fma_f16 v230, v230, v170, v174
    v_mfma_f32_16x16x32_f16 v[84:87], v[224:227], v[140:143], 0
    buffer_load_dwordx4 a[4:7], v1, s[40:43], s60 offen offset:1024 sc1
    v_pk_fma_f16 v231, v231, v171, v175
    v_pk_fma_f16 v232, v232, v168, v172
    v_mfma_f32_16x16x32_f16 v[56:59], v[220:223], v[144:147], 0
    ds_read_b128 v[140:143], v9 offset:5120
    v_pk_fma_f16 v233, v233, v169, v173
    v_mfma_f32_16x16x32_f16 v[88:91], v[224:227], v[144:147], 0
    v_pk_fma_f16 v234, v234, v170, v174
    v_pk_fma_f16 v235, v235, v171, v175
    v_mfma_f32_16x16x32_f16 v[60:63], v[220:223], v[148:151], 0
    ds_read_b128 v[144:147], v9 offset:6144
    buffer_load_dwordx4 v1, s[40:43], s93 offen offset:1024 sc1 lds
    v_mfma_f32_16x16x32_f16 v[92:95], v[224:227], v[148:151], 0
    s_waitcnt lgkmcnt(3)
    v_mfma_f32_16x16x32_f16 v[32:35], v[120:123], v[228:231], v[32:35]
    ds_read_b128 v[148:151], v153 offset:7168
    v_mfma_f32_16x16x32_f16 v[64:67], v[120:123], v[232:235], v[64:67]
    ds_read_b128 v[168:171], v167 offset:4096
    buffer_load_dwordx4 v1, s[40:43], s93 offen offset:2048 sc1 lds
    v_mfma_f32_16x16x32_f16 v[36:39], v[124:127], v[228:231], v[36:39]
    ds_read_b128 v[120:123], v10 offset:0
    ds_read_b128 v[176:179], v12 offset:2048
    v_mfma_f32_16x16x32_f16 v[68:71], v[124:127], v[232:235], v[68:71]
    ds_read_b128 v[172:175], v167 offset:4112
    v_mfma_f32_16x16x32_f16 v[40:43], v[128:131], v[228:231], v[40:43]
    ds_read_b128 v[124:127], v10 offset:1024
    buffer_load_dwordx4 a[8:11], v1, s[40:43], s57 offen offset:1024 sc1
    v_mfma_f32_16x16x32_f16 v[72:75], v[128:131], v[232:235], v[72:75]
    ds_read_b128 v[180:183], v12 offset:4096
    v_mfma_f32_16x16x32_f16 v[44:47], v[132:135], v[228:231], v[44:47]
    ds_read_b128 v[128:131], v10 offset:2048
    v_mfma_f32_16x16x32_f16 v[76:79], v[132:135], v[232:235], v[76:79]
    ds_read_b128 v[184:187], v12 offset:3072
    s_waitcnt lgkmcnt(8)
    v_mfma_f32_16x16x32_f16 v[48:51], v[136:139], v[228:231], v[48:51]
    ds_read_b128 v[132:135], v10 offset:3072
    buffer_load_dwordx4 v1, s[40:43], s93 offen offset:3072 sc1 lds
    s_waitcnt vmcnt(29)
    v_mfma_f32_16x16x32_f16 v[80:83], v[136:139], v[232:235], v[80:83]
    s_waitcnt lgkmcnt(5)
    v_pk_fma_f16 v236, v236, v168, v172
    v_pk_fma_f16 v237, v237, v169, v173
    v_mfma_f32_16x16x32_f16 v[52:55], v[228:231], v[140:143], v[52:55]
    ds_read_b128 v[136:139], v10 offset:4096
    ds_read_b128 v[188:191], v12 offset:5120
    v_pk_fma_f16 v238, v238, v170, v174
    v_mfma_f32_16x16x32_f16 v[84:87], v[232:235], v[140:143], v[84:87]
    buffer_load_dwordx4 a[12:15], v1, s[40:43], s61 offen offset:1024 sc1
    v_pk_fma_f16 v239, v239, v171, v175
    v_mfma_f32_16x16x32_f16 v[56:59], v[228:231], v[144:147], v[56:59]
    ds_read_b128 v[140:143], v10 offset:5120
    ds_read_b128 v[192:195], v12 offset:6144
    v_pk_fma_f16 v240, v240, v168, v172
    v_mfma_f32_16x16x32_f16 v[88:91], v[232:235], v[144:147], v[88:91]
    v_pk_fma_f16 v241, v241, v169, v173
    v_pk_fma_f16 v242, v242, v170, v174
    v_mfma_f32_16x16x32_f16 v[60:63], v[228:231], v[148:151], v[60:63]
    ds_read_b128 v[144:147], v10 offset:6144
    buffer_load_dwordx4 v[204:207], v1, s[40:43], s64 offen offset:1024 sc1
    v_pk_fma_f16 v243, v243, v171, v175
    v_mfma_f32_16x16x32_f16 v[92:95], v[232:235], v[148:151], v[92:95]
    ds_read_b128 v[196:199], v156 offset:7168
    s_waitcnt lgkmcnt(6)
    v_mfma_f32_16x16x32_f16 v[32:35], v[120:123], v[236:239], v[32:35]
    ds_read_b128 v[148:151], v154 offset:7168
    v_mfma_f32_16x16x32_f16 v[64:67], v[120:123], v[240:243], v[64:67]
    ds_read_b128 v[168:171], v167 offset:6144
    v_mfma_f32_16x16x32_f16 v[36:39], v[124:127], v[236:239], v[36:39]
    ds_read_b128 v[120:123], v11 offset:0
    v_mfma_f32_16x16x32_f16 v[68:71], v[124:127], v[240:243], v[68:71]
    ds_read_b128 v[172:175], v167 offset:6160
    v_mfma_f32_16x16x32_f16 v[40:43], v[128:131], v[236:239], v[40:43]
    ds_read_b128 v[124:127], v11 offset:1024
    v_mfma_f32_16x16x32_f16 v[72:75], v[128:131], v[240:243], v[72:75]
    s_waitcnt lgkmcnt(5)
    v_mfma_f32_16x16x32_f16 v[96:99], v[176:179], v[200:203], 0
    s_add_u32 m0, s82, 20480
    s_add_u32 s93, s84, 20480
    buffer_load_dwordx4 v1, s[40:43], s93 offen offset:0 sc1 lds
    v_mfma_f32_16x16x32_f16 v[44:47], v[132:135], v[236:239], v[44:47]
    ds_read_b128 v[128:131], v11 offset:2048
    s_waitcnt vmcnt(28)
    v_mfma_f32_16x16x32_f16 v[76:79], v[132:135], v[240:243], v[76:79]
    v_mfma_f32_16x16x32_f16 v[100:103], v[180:183], v[200:203], 0
    s_waitcnt lgkmcnt(2)
    v_pk_fma_f16 v244, v244, v168, v172
    v_mfma_f32_16x16x32_f16 v[48:51], v[136:139], v[236:239], v[48:51]
    ds_read_b128 v[132:135], v11 offset:3072
    v_pk_fma_f16 v245, v245, v169, v173
    v_mfma_f32_16x16x32_f16 v[80:83], v[136:139], v[240:243], v[80:83]
    buffer_load_dwordx4 a[16:19], v1, s[40:43], s58 offen offset:1024 sc1
    v_mfma_f32_16x16x32_f16 v[104:107], v[184:187], v[200:203], 0
    v_pk_fma_f16 v246, v246, v170, v174
    v_mfma_f32_16x16x32_f16 v[52:55], v[236:239], v[140:143], v[52:55]
    ds_read_b128 v[136:139], v11 offset:4096
    v_mfma_f32_16x16x32_f16 v[84:87], v[240:243], v[140:143], v[84:87]
    buffer_load_dwordx4 v1, s[40:43], s93 offen offset:1024 sc1 lds
    v_pk_fma_f16 v247, v247, v171, v175
    v_mfma_f32_16x16x32_f16 v[108:111], v[200:203], v[188:191], 0
    v_pk_fma_f16 v248, v248, v168, v172
    v_mfma_f32_16x16x32_f16 v[56:59], v[236:239], v[144:147], v[56:59]
    ds_read_b128 v[140:143], v11 offset:5120
    v_mfma_f32_16x16x32_f16 v[88:91], v[240:243], v[144:147], v[88:91]
    buffer_load_dwordx4 a[20:23], v1, s[40:43], s62 offen offset:1024 sc1
    v_pk_fma_f16 v249, v249, v169, v173
    v_mfma_f32_16x16x32_f16 v[112:115], v[200:203], v[192:195], 0
    v_pk_fma_f16 v250, v250, v170, v174
    v_mfma_f32_16x16x32_f16 v[60:63], v[236:239], v[148:151], v[60:63]
    ds_read_b128 v[144:147], v11 offset:6144
    v_mfma_f32_16x16x32_f16 v[92:95], v[240:243], v[148:151], v[92:95]
    buffer_load_dwordx4 v1, s[40:43], s93 offen offset:2048 sc1 lds
    v_pk_fma_f16 v251, v251, v171, v175
    v_mfma_f32_16x16x32_f16 v[116:119], v[200:203], v[196:199], 0
    s_waitcnt vmcnt(15)
    s_barrier
    s_waitcnt lgkmcnt(3)
    v_mfma_f32_16x16x32_f16 v[32:35], v[120:123], v[244:247], v[32:35]
    ds_read_b128 v[148:151], v155 offset:7168
    s_waitcnt vmcnt(11)
    v_mfma_f32_16x16x32_f16 v[64:67], v[120:123], v[248:251], v[64:67]
    ds_read_b128 v[168:171], v167 offset:128
    s_lshl_b32 s88, s15, 2
    s_add_u32 s88, s88, 0x1000
    v_mov_b32 v14, s6
    s_cmp_eq_u32 s3, 1
    s_cselect_b32 s89, 1, 0
    s_and_b32 exec_lo, s89, s85
    s_mov_b32 exec_hi, 0
    buffer_store_dword v14, off, s[40:43], s88 sc1
    s_mov_b64 exec, -1
    v_accvgpr_read_b32 v220, a0
    v_mfma_f32_16x16x32_f16 v[36:39], v[124:127], v[244:247], v[36:39]
    ds_read_b128 v[120:123], v8 offset:7680
    v_accvgpr_read_b32 v221, a1
    v_mfma_f32_16x16x32_f16 v[68:71], v[124:127], v[248:251], v[68:71]
    ds_read_b128 v[172:175], v167 offset:144
    v_accvgpr_read_b32 v222, a2
    v_accvgpr_read_b32 v223, a3
    v_mfma_f32_16x16x32_f16 v[40:43], v[128:131], v[244:247], v[40:43]
    ds_read_b128 v[124:127], v8 offset:8704
    buffer_load_dwordx4 v1, s[40:43], s93 offen offset:3072 sc1 lds
    v_mfma_f32_16x16x32_f16 v[72:75], v[128:131], v[248:251], v[72:75]
    ds_read_b128 v[176:179], v12 offset:9728
    v_accvgpr_read_b32 v224, a4
    v_mfma_f32_16x16x32_f16 v[44:47], v[132:135], v[244:247], v[44:47]
    ds_read_b128 v[128:131], v8 offset:9728
    v_accvgpr_read_b32 v225, a5
    v_accvgpr_read_b32 v226, a6
    v_mfma_f32_16x16x32_f16 v[76:79], v[132:135], v[248:251], v[76:79]
    v_accvgpr_read_b32 v227, a7
    s_waitcnt lgkmcnt(6)
    v_mfma_f32_16x16x32_f16 v[48:51], v[136:139], v[244:247], v[48:51]
    ds_read_b128 v[132:135], v8 offset:10752
    buffer_load_dwordx4 a[24:27], v1, s[40:43], s59 offen offset:1024 sc1
    s_waitcnt lgkmcnt(4)
    v_pk_fma_f16 v220, v220, v168, v172
    v_mfma_f32_16x16x32_f16 v[80:83], v[136:139], v[248:251], v[80:83]
    ds_read_b128 v[180:183], v12 offset:11776
    v_pk_fma_f16 v221, v221, v169, v173
    v_mfma_f32_16x16x32_f16 v[52:55], v[244:247], v[140:143], v[52:55]
    ds_read_b128 v[136:139], v8 offset:11776
    v_pk_fma_f16 v222, v222, v170, v174
    v_mfma_f32_16x16x32_f16 v[84:87], v[248:251], v[140:143], v[84:87]
    s_add_u32 m0, s82, 24576
    s_add_u32 s93, s84, 24576
    buffer_load_dwordx4 v1, s[40:43], s93 offen offset:0 sc1 lds
    v_pk_fma_f16 v223, v223, v171, v175
    v_pk_fma_f16 v224, v224, v168, v172
    v_mfma_f32_16x16x32_f16 v[56:59], v[244:247], v[144:147], v[56:59]
    ds_read_b128 v[140:143], v8 offset:12800
    v_pk_fma_f16 v225, v225, v169, v173
    v_mfma_f32_16x16x32_f16 v[88:91], v[248:251], v[144:147], v[88:91]
    ds_read_b128 v[184:187], v12 offset:10752
    v_pk_fma_f16 v226, v226, v170, v174
    v_pk_fma_f16 v227, v227, v171, v175
    v_mfma_f32_16x16x32_f16 v[60:63], v[244:247], v[148:151], v[60:63]
    ds_read_b128 v[144:147], v8 offset:13824
    buffer_load_dwordx4 a[28:31], v1, s[40:43], s63 offen offset:1024 sc1
    v_mfma_f32_16x16x32_f16 v[92:95], v[248:251], v[148:151], v[92:95]
    s_waitcnt lgkmcnt(5)
    v_mfma_f32_16x16x32_f16 v[32:35], v[120:123], v[220:223], v[32:35]
    ds_read_b128 v[148:151], v152 offset:14848
    s_waitcnt vmcnt(11)
    v_accvgpr_read_b32 v228, a8
    v_mfma_f32_16x16x32_f16 v[64:67], v[120:123], v[224:227], v[64:67]
    ds_read_b128 v[168:171], v167 offset:2176
    buffer_load_dwordx4 v1, s[40:43], s93 offen offset:1024 sc1 lds
    v_accvgpr_read_b32 v229, a9
    v_mfma_f32_16x16x32_f16 v[36:39], v[124:127], v[220:223], v[36:39]
    ds_read_b128 v[120:123], v9 offset:7680
    ds_read_b128 v[188:191], v12 offset:12800
    v_mfma_f32_16x16x32_f16 v[68:71], v[124:127], v[224:227], v[68:71]
    ds_read_b128 v[172:175], v167 offset:2192
    v_accvgpr_read_b32 v230, a10
    v_accvgpr_read_b32 v231, a11
    v_mfma_f32_16x16x32_f16 v[40:43], v[128:131], v[220:223], v[40:43]
    ds_read_b128 v[124:127], v9 offset:8704
    buffer_load_dwordx4 a[32:35], v1, s[40:43], s56 offen offset:2048 sc1
    v_accvgpr_read_b32 v232, a12
    v_mfma_f32_16x16x32_f16 v[72:75], v[128:131], v[224:227], v[72:75]
    ds_read_b128 v[236:239], v6 offset:128
    v_accvgpr_read_b32 v233, a13
    v_accvgpr_read_b32 v234, a14
    v_mfma_f32_16x16x32_f16 v[44:47], v[132:135], v[220:223], v[44:47]
    ds_read_b128 v[128:131], v9 offset:9728
    v_accvgpr_read_b32 v235, a15
    s_waitcnt lgkmcnt(3)
    v_pk_fma_f16 v228, v228, v168, v172
    v_mfma_f32_16x16x32_f16 v[76:79], v[132:135], v[224:227], v[76:79]
    ds_read_b128 v[240:243], v6 offset:144
    v_mfma_f32_16x16x32_f16 v[48:51], v[136:139], v[220:223], v[48:51]
    ds_read_b128 v[132:135], v9 offset:10752
    buffer_load_dwordx4 v1, s[40:43], s93 offen offset:2048 sc1 lds
    v_pk_fma_f16 v229, v229, v169, v173
    v_mfma_f32_16x16x32_f16 v[80:83], v[136:139], v[224:227], v[80:83]
    ds_read_b128 v[192:195], v12 offset:13824
    v_pk_fma_f16 v230, v230, v170, v174
    v_pk_fma_f16 v231, v231, v171, v175
    v_mfma_f32_16x16x32_f16 v[52:55], v[220:223], v[140:143], v[52:55]
    ds_read_b128 v[136:139], v9 offset:11776
    v_pk_fma_f16 v232, v232, v168, v172
    v_pk_fma_f16 v233, v233, v169, v173
    v_mfma_f32_16x16x32_f16 v[84:87], v[224:227], v[140:143], v[84:87]
    buffer_load_dwordx4 a[36:39], v1, s[40:43], s60 offen offset:2048 sc1
    v_pk_fma_f16 v234, v234, v170, v174
    v_pk_fma_f16 v235, v235, v171, v175
    v_mfma_f32_16x16x32_f16 v[56:59], v[220:223], v[144:147], v[56:59]
    ds_read_b128 v[140:143], v9 offset:12800
    s_waitcnt vmcnt(14)
    s_waitcnt lgkmcnt(4)
    v_pk_fma_f16 v204, v204, v236, v240
    v_mfma_f32_16x16x32_f16 v[88:91], v[224:227], v[144:147], v[88:91]
    ds_read_b128 v[196:199], v156 offset:14848
    v_pk_fma_f16 v205, v205, v237, v241
    v_pk_fma_f16 v206, v206, v238, v242
    v_mfma_f32_16x16x32_f16 v[60:63], v[220:223], v[148:151], v[60:63]
    ds_read_b128 v[144:147], v9 offset:13824
    buffer_load_dwordx4 v[208:211], v1, s[40:43], s64 offen offset:2048 sc1
    v_pk_fma_f16 v207, v207, v239, v243
    v_mfma_f32_16x16x32_f16 v[92:95], v[224:227], v[148:151], v[92:95]
    s_waitcnt lgkmcnt(5)
    v_mfma_f32_16x16x32_f16 v[32:35], v[120:123], v[228:231], v[32:35]
    ds_read_b128 v[148:151], v153 offset:14848
    s_waitcnt vmcnt(11)
    v_mfma_f32_16x16x32_f16 v[64:67], v[120:123], v[232:235], v[64:67]
    ds_read_b128 v[168:171], v167 offset:4224
    v_accvgpr_read_b32 v220, a16
    v_mfma_f32_16x16x32_f16 v[36:39], v[124:127], v[228:231], v[36:39]
    ds_read_b128 v[120:123], v10 offset:7680
    v_mfma_f32_16x16x32_f16 v[68:71], v[124:127], v[232:235], v[68:71]
    ds_read_b128 v[172:175], v167 offset:4240
    v_accvgpr_read_b32 v221, a17
    v_mfma_f32_16x16x32_f16 v[40:43], v[128:131], v[228:231], v[40:43]
    ds_read_b128 v[124:127], v10 offset:8704
    v_accvgpr_read_b32 v222, a18
    v_mfma_f32_16x16x32_f16 v[72:75], v[128:131], v[232:235], v[72:75]
    v_accvgpr_read_b32 v223, a19
    s_waitcnt lgkmcnt(6)
    v_mfma_f32_16x16x32_f16 v[96:99], v[176:179], v[204:207], v[96:99]
    v_accvgpr_read_b32 v224, a20
    v_mfma_f32_16x16x32_f16 v[44:47], v[132:135], v[228:231], v[44:47]
    ds_read_b128 v[128:131], v10 offset:9728
    v_mfma_f32_16x16x32_f16 v[76:79], v[132:135], v[232:235], v[76:79]
    buffer_load_dwordx4 v1, s[40:43], s93 offen offset:3072 sc1 lds
    v_accvgpr_read_b32 v225, a21
    v_mfma_f32_16x16x32_f16 v[100:103], v[180:183], v[204:207], v[100:103]
    v_accvgpr_read_b32 v226, a22
    s_waitcnt lgkmcnt(5)
    v_mfma_f32_16x16x32_f16 v[48:51], v[136:139], v[228:231], v[48:51]
    ds_read_b128 v[132:135], v10 offset:10752
    v_accvgpr_read_b32 v227, a23
    v_mfma_f32_16x16x32_f16 v[80:83], v[136:139], v[232:235], v[80:83]
    s_waitcnt lgkmcnt(3)
    v_pk_fma_f16 v220, v220, v168, v172
    v_mfma_f32_16x16x32_f16 v[104:107], v[184:187], v[204:207], v[104:107]
    buffer_load_dwordx4 a[40:43], v1, s[40:43], s57 offen offset:2048 sc1
    v_pk_fma_f16 v221, v221, v169, v173
    v_mfma_f32_16x16x32_f16 v[52:55], v[228:231], v[140:143], v[52:55]
    ds_read_b128 v[136:139], v10 offset:11776
    v_mfma_f32_16x16x32_f16 v[84:87], v[232:235], v[140:143], v[84:87]
    v_pk_fma_f16 v222, v222, v170, v174
    v_mfma_f32_16x16x32_f16 v[108:111], v[204:207], v[188:191], v[108:111]
    s_add_u32 m0, s82, 28672
    s_add_u32 s93, s84, 28672
    buffer_load_dwordx4 v1, s[40:43], s93 offen offset:0 sc1 lds
    v_pk_fma_f16 v223, v223, v171, v175
    v_mfma_f32_16x16x32_f16 v[56:59], v[228:231], v[144:147], v[56:59]
    ds_read_b128 v[140:143], v10 offset:12800
    v_pk_fma_f16 v224, v224, v168, v172
    v_mfma_f32_16x16x32_f16 v[88:91], v[232:235], v[144:147], v[88:91]
    v_pk_fma_f16 v225, v225, v169, v173
    v_mfma_f32_16x16x32_f16 v[112:115], v[204:207], v[192:195], v[112:115]
    buffer_load_dwordx4 a[44:47], v1, s[40:43], s61 offen offset:2048 sc1
    v_mfma_f32_16x16x32_f16 v[60:63], v[228:231], v[148:151], v[60:63]
    ds_read_b128 v[144:147], v10 offset:13824
    v_pk_fma_f16 v226, v226, v170, v174
    v_mfma_f32_16x16x32_f16 v[92:95], v[232:235], v[148:151], v[92:95]
    v_pk_fma_f16 v227, v227, v171, v175
    v_mfma_f32_16x16x32_f16 v[116:119], v[204:207], v[196:199], v[116:119]
    s_waitcnt vmcnt(14)
    s_waitcnt lgkmcnt(3)
    v_mfma_f32_16x16x32_f16 v[32:35], v[120:123], v[220:223], v[32:35]
    ds_read_b128 v[148:151], v154 offset:14848
    s_waitcnt vmcnt(9)
    v_mfma_f32_16x16x32_f16 v[64:67], v[120:123], v[224:227], v[64:67]
    ds_read_b128 v[168:171], v167 offset:6272
    v_accvgpr_read_b32 v228, a24
    v_accvgpr_read_b32 v229, a25
    v_mfma_f32_16x16x32_f16 v[36:39], v[124:127], v[220:223], v[36:39]
    ds_read_b128 v[120:123], v11 offset:7680
    ds_read_b128 v[176:179], v12 offset:17408
    v_mfma_f32_16x16x32_f16 v[68:71], v[124:127], v[224:227], v[68:71]
    ds_read_b128 v[172:175], v167 offset:6288
    v_accvgpr_read_b32 v230, a26
    v_mfma_f32_16x16x32_f16 v[40:43], v[128:131], v[220:223], v[40:43]
    ds_read_b128 v[124:127], v11 offset:8704
    v_accvgpr_read_b32 v231, a27
    v_accvgpr_read_b32 v232, a28
    v_mfma_f32_16x16x32_f16 v[72:75], v[128:131], v[224:227], v[72:75]
    buffer_load_dwordx4 v1, s[40:43], s93 offen offset:1024 sc1 lds
    v_accvgpr_read_b32 v233, a29
    v_mfma_f32_16x16x32_f16 v[44:47], v[132:135], v[220:223], v[44:47]
    ds_read_b128 v[128:131], v11 offset:9728
    v_accvgpr_read_b32 v234, a30
    v_mfma_f32_16x16x32_f16 v[76:79], v[132:135], v[224:227], v[76:79]
    v_accvgpr_read_b32 v235, a31
    s_waitcnt lgkmcnt(2)
    v_pk_fma_f16 v228, v228, v168, v172
    v_mfma_f32_16x16x32_f16 v[48:51], v[136:139], v[220:223], v[48:51]
    ds_read_b128 v[132:135], v11 offset:10752
    ds_read_b128 v[180:183], v12 offset:19456
    v_mfma_f32_16x16x32_f16 v[80:83], v[136:139], v[224:227], v[80:83]
    buffer_load_dwordx4 a[48:51], v1, s[40:43], s58 offen offset:2048 sc1
    v_pk_fma_f16 v229, v229, v169, v173
    v_mfma_f32_16x16x32_f16 v[52:55], v[220:223], v[140:143], v[52:55]
    ds_read_b128 v[136:139], v11 offset:11776
    v_pk_fma_f16 v230, v230, v170, v174
    v_pk_fma_f16 v231, v231, v171, v175
    v_mfma_f32_16x16x32_f16 v[84:87], v[224:227], v[140:143], v[84:87]
    buffer_load_dwordx4 v1, s[40:43], s93 offen offset:2048 sc1 lds
    v_pk_fma_f16 v232, v232, v168, v172
    v_mfma_f32_16x16x32_f16 v[56:59], v[220:223], v[144:147], v[56:59]
    ds_read_b128 v[140:143], v11 offset:12800
    v_pk_fma_f16 v233, v233, v169, v173
    v_mfma_f32_16x16x32_f16 v[88:91], v[224:227], v[144:147], v[88:91]
    buffer_load_dwordx4 a[52:55], v1, s[40:43], s62 offen offset:2048 sc1
    ds_read_b128 v[184:187], v12 offset:18432
    v_pk_fma_f16 v234, v234, v170, v174
    v_mfma_f32_16x16x32_f16 v[60:63], v[220:223], v[148:151], v[60:63]
    ds_read_b128 v[144:147], v11 offset:13824
    v_pk_fma_f16 v235, v235, v171, v175
    v_mfma_f32_16x16x32_f16 v[92:95], v[224:227], v[148:151], v[92:95]
    s_barrier
    s_waitcnt lgkmcnt(5)
    v_mfma_f32_16x16x32_f16 v[32:35], v[120:123], v[228:231], v[32:35]
    ds_read_b128 v[148:151], v155 offset:14848
    s_waitcnt vmcnt(9)
    v_accvgpr_read_b32 v220, a32
    v_mfma_f32_16x16x32_f16 v[64:67], v[120:123], v[232:235], v[64:67]
    ds_read_b128 v[168:171], v167 offset:256
    buffer_load_dwordx4 v1, s[40:43], s93 offen offset:3072 sc1 lds
    v_accvgpr_read_b32 v221, a33
    v_mfma_f32_16x16x32_f16 v[36:39], v[124:127], v[228:231], v[36:39]
    ds_read_b128 v[120:123], v8 offset:15360
    ds_read_b128 v[188:191], v12 offset:20480
    v_mfma_f32_16x16x32_f16 v[68:71], v[124:127], v[232:235], v[68:71]
    ds_read_b128 v[172:175], v167 offset:272
    v_accvgpr_read_b32 v222, a34
    v_accvgpr_read_b32 v223, a35
    v_mfma_f32_16x16x32_f16 v[40:43], v[128:131], v[228:231], v[40:43]
    ds_read_b128 v[124:127], v8 offset:16384
    buffer_load_dwordx4 a[56:59], v1, s[40:43], s59 offen offset:2048 sc1
    v_accvgpr_read_b32 v224, a36
    v_mfma_f32_16x16x32_f16 v[72:75], v[128:131], v[232:235], v[72:75]
    ds_read_b128 v[236:239], v6 offset:256
    v_accvgpr_read_b32 v225, a37
    v_accvgpr_read_b32 v226, a38
    v_mfma_f32_16x16x32_f16 v[44:47], v[132:135], v[228:231], v[44:47]
    ds_read_b128 v[128:131], v8 offset:17408
    v_accvgpr_read_b32 v227, a39
    s_waitcnt lgkmcnt(3)
    v_pk_fma_f16 v220, v220, v168, v172
    v_mfma_f32_16x16x32_f16 v[76:79], v[132:135], v[232:235], v[76:79]
    ds_read_b128 v[240:243], v6 offset:272
    v_mfma_f32_16x16x32_f16 v[48:51], v[136:139], v[228:231], v[48:51]
    ds_read_b128 v[132:135], v8 offset:18432
    s_add_u32 m0, s82, 32768
    s_add_u32 s93, s84, 32768
    buffer_load_dwordx4 v1, s[40:43], s93 offen offset:0 sc1 lds
    v_pk_fma_f16 v221, v221, v169, v173
    v_mfma_f32_16x16x32_f16 v[80:83], v[136:139], v[232:235], v[80:83]
    ds_read_b128 v[192:195], v12 offset:21504
    v_pk_fma_f16 v222, v222, v170, v174
    v_pk_fma_f16 v223, v223, v171, v175
    v_mfma_f32_16x16x32_f16 v[52:55], v[228:231], v[140:143], v[52:55]
    ds_read_b128 v[136:139], v8 offset:19456
    v_pk_fma_f16 v224, v224, v168, v172
    v_pk_fma_f16 v225, v225, v169, v173
    v_mfma_f32_16x16x32_f16 v[84:87], v[232:235], v[140:143], v[84:87]
    buffer_load_dwordx4 a[60:63], v1, s[40:43], s63 offen offset:2048 sc1
    v_pk_fma_f16 v226, v226, v170, v174
    v_pk_fma_f16 v227, v227, v171, v175
    v_mfma_f32_16x16x32_f16 v[56:59], v[228:231], v[144:147], v[56:59]
    ds_read_b128 v[140:143], v8 offset:20480
    s_waitcnt vmcnt(12)
    s_waitcnt lgkmcnt(4)
    v_pk_fma_f16 v208, v208, v236, v240
    v_mfma_f32_16x16x32_f16 v[88:91], v[232:235], v[144:147], v[88:91]
    ds_read_b128 v[196:199], v156 offset:22528
    v_pk_fma_f16 v209, v209, v237, v241
    v_pk_fma_f16 v210, v210, v238, v242
    v_mfma_f32_16x16x32_f16 v[60:63], v[228:231], v[148:151], v[60:63]
    ds_read_b128 v[144:147], v8 offset:21504
    buffer_load_dwordx4 v[212:215], v1, s[40:43], s64 offen offset:3072 sc1
    v_pk_fma_f16 v211, v211, v239, v243
    v_mfma_f32_16x16x32_f16 v[92:95], v[232:235], v[148:151], v[92:95]
    s_waitcnt lgkmcnt(5)
    v_mfma_f32_16x16x32_f16 v[32:35], v[120:123], v[220:223], v[32:35]
    ds_read_b128 v[148:151], v152 offset:22528
    s_waitcnt vmcnt(9)
    v_mfma_f32_16x16x32_f16 v[64:67], v[120:123], v[224:227], v[64:67]
    ds_read_b128 v[168:171], v167 offset:2304
    v_accvgpr_read_b32 v228, a40
    v_mfma_f32_16x16x32_f16 v[36:39], v[124:127], v[220:223], v[36:39]
    ds_read_b128 v[120:123], v9 offset:15360
    v_mfma_f32_16x16x32_f16 v[68:71], v[124:127], v[224:227], v[68:71]
    ds_read_b128 v[172:175], v167 offset:2320
    v_accvgpr_read_b32 v229, a41
    v_mfma_f32_16x16x32_f16 v[40:43], v[128:131], v[220:223], v[40:43]
    ds_read_b128 v[124:127], v9 offset:16384
    v_accvgpr_read_b32 v230, a42
    v_mfma_f32_16x16x32_f16 v[72:75], v[128:131], v[224:227], v[72:75]
    v_accvgpr_read_b32 v231, a43
    s_waitcnt lgkmcnt(6)
    v_mfma_f32_16x16x32_f16 v[96:99], v[176:179], v[208:211], v[96:99]
    v_accvgpr_read_b32 v232, a44
    v_mfma_f32_16x16x32_f16 v[44:47], v[132:135], v[220:223], v[44:47]
    ds_read_b128 v[128:131], v9 offset:17408
    v_mfma_f32_16x16x32_f16 v[76:79], v[132:135], v[224:227], v[76:79]
    buffer_load_dwordx4 v1, s[40:43], s93 offen offset:1024 sc1 lds
    v_accvgpr_read_b32 v233, a45
    v_mfma_f32_16x16x32_f16 v[100:103], v[180:183], v[208:211], v[100:103]
    v_accvgpr_read_b32 v234, a46
    s_waitcnt lgkmcnt(5)
    v_mfma_f32_16x16x32_f16 v[48:51], v[136:139], v[220:223], v[48:51]
    ds_read_b128 v[132:135], v9 offset:18432
    v_accvgpr_read_b32 v235, a47
    v_mfma_f32_16x16x32_f16 v[80:83], v[136:139], v[224:227], v[80:83]
    s_waitcnt lgkmcnt(3)
    v_pk_fma_f16 v228, v228, v168, v172
    v_mfma_f32_16x16x32_f16 v[104:107], v[184:187], v[208:211], v[104:107]
    buffer_load_dwordx4 a[64:67], v1, s[40:43], s56 offen offset:3072 sc1
    v_pk_fma_f16 v229, v229, v169, v173
    v_mfma_f32_16x16x32_f16 v[52:55], v[220:223], v[140:143], v[52:55]
    ds_read_b128 v[136:139], v9 offset:19456
    v_mfma_f32_16x16x32_f16 v[84:87], v[224:227], v[140:143], v[84:87]
    v_pk_fma_f16 v230, v230, v170, v174
    v_mfma_f32_16x16x32_f16 v[108:111], v[208:211], v[188:191], v[108:111]
    buffer_load_dwordx4 v1, s[40:43], s93 offen offset:2048 sc1 lds
    v_pk_fma_f16 v231, v231, v171, v175
    v_mfma_f32_16x16x32_f16 v[56:59], v[220:223], v[144:147], v[56:59]
    ds_read_b128 v[140:143], v9 offset:20480
    v_pk_fma_f16 v232, v232, v168, v172
    v_mfma_f32_16x16x32_f16 v[88:91], v[224:227], v[144:147], v[88:91]
    v_pk_fma_f16 v233, v233, v169, v173
    v_mfma_f32_16x16x32_f16 v[112:115], v[208:211], v[192:195], v[112:115]
    buffer_load_dwordx4 a[68:71], v1, s[40:43], s60 offen offset:3072 sc1
    v_mfma_f32_16x16x32_f16 v[60:63], v[220:223], v[148:151], v[60:63]
    ds_read_b128 v[144:147], v9 offset:21504
    v_pk_fma_f16 v234, v234, v170, v174
    v_mfma_f32_16x16x32_f16 v[92:95], v[224:227], v[148:151], v[92:95]
    v_pk_fma_f16 v235, v235, v171, v175
    v_mfma_f32_16x16x32_f16 v[116:119], v[208:211], v[196:199], v[116:119]
    s_waitcnt vmcnt(12)
    s_waitcnt lgkmcnt(3)
    v_mfma_f32_16x16x32_f16 v[32:35], v[120:123], v[228:231], v[32:35]
    ds_read_b128 v[148:151], v153 offset:22528
    s_waitcnt vmcnt(9)
    v_mfma_f32_16x16x32_f16 v[64:67], v[120:123], v[232:235], v[64:67]
    ds_read_b128 v[168:171], v167 offset:4352
    buffer_load_dwordx4 v1, s[40:43], s93 offen offset:3072 sc1 lds
    v_accvgpr_read_b32 v220, a48
    v_mfma_f32_16x16x32_f16 v[36:39], v[124:127], v[228:231], v[36:39]
    ds_read_b128 v[120:123], v10 offset:15360
    v_accvgpr_read_b32 v221, a49
    v_mfma_f32_16x16x32_f16 v[68:71], v[124:127], v[232:235], v[68:71]
    ds_read_b128 v[172:175], v167 offset:4368
    v_accvgpr_read_b32 v222, a50
    v_accvgpr_read_b32 v223, a51
    v_mfma_f32_16x16x32_f16 v[40:43], v[128:131], v[228:231], v[40:43]
    ds_read_b128 v[124:127], v10 offset:16384
    buffer_load_dwordx4 a[72:75], v1, s[40:43], s57 offen offset:3072 sc1
    v_mfma_f32_16x16x32_f16 v[72:75], v[128:131], v[232:235], v[72:75]
    ds_read_b128 v[176:179], v12 offset:25088
    v_accvgpr_read_b32 v224, a52
    v_mfma_f32_16x16x32_f16 v[44:47], v[132:135], v[228:231], v[44:47]
    ds_read_b128 v[128:131], v10 offset:17408
    v_accvgpr_read_b32 v225, a53
    v_accvgpr_read_b32 v226, a54
    v_mfma_f32_16x16x32_f16 v[76:79], v[132:135], v[232:235], v[76:79]
    v_accvgpr_read_b32 v227, a55
    s_waitcnt lgkmcnt(6)
    v_mfma_f32_16x16x32_f16 v[48:51], v[136:139], v[228:231], v[48:51]
    ds_read_b128 v[132:135], v10 offset:18432
    s_add_u32 m0, s82, 36864
    s_add_u32 s93, s84, 36864
    buffer_load_dwordx4 v1, s[40:43], s93 offen offset:0 sc1 lds
    s_waitcnt lgkmcnt(4)
    v_pk_fma_f16 v220, v220, v168, v172
    v_mfma_f32_16x16x32_f16 v[80:83], v[136:139], v[232:235], v[80:83]
    ds_read_b128 v[180:183], v12 offset:27136
    v_pk_fma_f16 v221, v221, v169, v173
    v_mfma_f32_16x16x32_f16 v[52:55], v[228:231], v[140:143], v[52:55]
    ds_read_b128 v[136:139], v10 offset:19456
    v_pk_fma_f16 v222, v222, v170, v174
    v_mfma_f32_16x16x32_f16 v[84:87], v[232:235], v[140:143], v[84:87]
    buffer_load_dwordx4 a[76:79], v1, s[40:43], s61 offen offset:3072 sc1
    v_pk_fma_f16 v223, v223, v171, v175
    v_pk_fma_f16 v224, v224, v168, v172
    v_mfma_f32_16x16x32_f16 v[56:59], v[228:231], v[144:147], v[56:59]
    ds_read_b128 v[140:143], v10 offset:20480
    v_pk_fma_f16 v225, v225, v169, v173
    v_mfma_f32_16x16x32_f16 v[88:91], v[232:235], v[144:147], v[88:91]
    ds_read_b128 v[184:187], v12 offset:26112
    v_pk_fma_f16 v226, v226, v170, v174
    v_pk_fma_f16 v227, v227, v171, v175
    v_mfma_f32_16x16x32_f16 v[60:63], v[228:231], v[148:151], v[60:63]
    ds_read_b128 v[144:147], v10 offset:21504
    buffer_load_dwordx4 v[216:219], v5, s[40:43], s64 offen offset:0 sc1
    v_mfma_f32_16x16x32_f16 v[92:95], v[232:235], v[148:151], v[92:95]
    s_waitcnt lgkmcnt(5)
    v_mfma_f32_16x16x32_f16 v[32:35], v[120:123], v[220:223], v[32:35]
    ds_read_b128 v[148:151], v154 offset:22528
    s_waitcnt vmcnt(10)
    v_accvgpr_read_b32 v228, a56
    v_mfma_f32_16x16x32_f16 v[64:67], v[120:123], v[224:227], v[64:67]
    ds_read_b128 v[168:171], v167 offset:6400
    v_accvgpr_read_b32 v229, a57
    v_mfma_f32_16x16x32_f16 v[36:39], v[124:127], v[220:223], v[36:39]
    ds_read_b128 v[120:123], v11 offset:15360
    ds_read_b128 v[188:191], v12 offset:28160
    v_accvgpr_read_b32 v230, a58
    v_mfma_f32_16x16x32_f16 v[68:71], v[124:127], v[224:227], v[68:71]
    ds_read_b128 v[172:175], v167 offset:6416
    v_accvgpr_read_b32 v231, a59
    v_accvgpr_read_b32 v232, a60
    v_mfma_f32_16x16x32_f16 v[40:43], v[128:131], v[220:223], v[40:43]
    ds_read_b128 v[124:127], v11 offset:16384
    v_accvgpr_read_b32 v233, a61
    v_mfma_f32_16x16x32_f16 v[72:75], v[128:131], v[224:227], v[72:75]
    ds_read_b128 v[236:239], v6 offset:384
    v_accvgpr_read_b32 v234, a62
    v_accvgpr_read_b32 v235, a63
    v_mfma_f32_16x16x32_f16 v[44:47], v[132:135], v[220:223], v[44:47]
    ds_read_b128 v[128:131], v11 offset:17408
    s_waitcnt lgkmcnt(3)
    v_pk_fma_f16 v228, v228, v168, v172
    v_pk_fma_f16 v229, v229, v169, v173
    v_mfma_f32_16x16x32_f16 v[76:79], v[132:135], v[224:227], v[76:79]
    ds_read_b128 v[240:243], v6 offset:400
    v_mfma_f32_16x16x32_f16 v[48:51], v[136:139], v[220:223], v[48:51]
    ds_read_b128 v[132:135], v11 offset:18432
    ds_read_b128 v[192:195], v12 offset:29184
    v_pk_fma_f16 v230, v230, v170, v174
    v_mfma_f32_16x16x32_f16 v[80:83], v[136:139], v[224:227], v[80:83]
    s_mov_b32 exec_hi, 0
    buffer_load_dwordx4 v1, s[40:43], s93 offen offset:1024 sc1 lds
    s_mov_b64 exec, -1
    v_pk_fma_f16 v231, v231, v171, v175
    v_pk_fma_f16 v232, v232, v168, v172
    v_mfma_f32_16x16x32_f16 v[52:55], v[220:223], v[140:143], v[52:55]
    ds_read_b128 v[136:139], v11 offset:19456
    v_pk_fma_f16 v233, v233, v169, v173
    v_mfma_f32_16x16x32_f16 v[84:87], v[224:227], v[140:143], v[84:87]
    buffer_load_dwordx4 a[80:83], v1, s[40:43], s58 offen offset:3072 sc1
    v_pk_fma_f16 v234, v234, v170, v174
    v_pk_fma_f16 v235, v235, v171, v175
    v_mfma_f32_16x16x32_f16 v[56:59], v[220:223], v[144:147], v[56:59]
    ds_read_b128 v[140:143], v11 offset:20480
    s_waitcnt vmcnt(11)
    s_waitcnt lgkmcnt(4)
    v_pk_fma_f16 v212, v212, v236, v240
    v_pk_fma_f16 v213, v213, v237, v241
    v_mfma_f32_16x16x32_f16 v[88:91], v[224:227], v[144:147], v[88:91]
    buffer_load_dwordx4 a[84:87], v1, s[40:43], s62 offen offset:3072 sc1
    ds_read_b128 v[196:199], v156 offset:30208
    v_mfma_f32_16x16x32_f16 v[60:63], v[220:223], v[148:151], v[60:63]
    ds_read_b128 v[144:147], v11 offset:21504
    v_pk_fma_f16 v214, v214, v238, v242
    v_pk_fma_f16 v215, v215, v239, v243
    v_mfma_f32_16x16x32_f16 v[92:95], v[224:227], v[148:151], v[92:95]
    s_barrier
    s_waitcnt lgkmcnt(5)
    v_mfma_f32_16x16x32_f16 v[32:35], v[120:123], v[228:231], v[32:35]
    ds_read_b128 v[148:151], v155 offset:22528
    s_waitcnt vmcnt(8)
    v_mfma_f32_16x16x32_f16 v[64:67], v[120:123], v[232:235], v[64:67]
    ds_read_b128 v[168:171], v167 offset:384
    v_accvgpr_read_b32 v220, a64
    v_mfma_f32_16x16x32_f16 v[36:39], v[124:127], v[228:231], v[36:39]
    ds_read_b128 v[120:123], v8 offset:23040
    v_mfma_f32_16x16x32_f16 v[68:71], v[124:127], v[232:235], v[68:71]
    ds_read_b128 v[172:175], v167 offset:400
    v_accvgpr_read_b32 v221, a65
    v_mfma_f32_16x16x32_f16 v[40:43], v[128:131], v[228:231], v[40:43]
    ds_read_b128 v[124:127], v8 offset:24064
    v_accvgpr_read_b32 v222, a66
    v_mfma_f32_16x16x32_f16 v[72:75], v[128:131], v[232:235], v[72:75]
    v_accvgpr_read_b32 v223, a67
    s_waitcnt lgkmcnt(6)
    v_mfma_f32_16x16x32_f16 v[96:99], v[176:179], v[212:215], v[96:99]
    v_accvgpr_read_b32 v224, a68
    v_mfma_f32_16x16x32_f16 v[44:47], v[132:135], v[228:231], v[44:47]
    ds_read_b128 v[128:131], v8 offset:25088
    v_mfma_f32_16x16x32_f16 v[76:79], v[132:135], v[232:235], v[76:79]
    buffer_load_dwordx4 a[88:91], v1, s[40:43], s59 offen offset:3072 sc1
    v_accvgpr_read_b32 v225, a69
    v_mfma_f32_16x16x32_f16 v[100:103], v[180:183], v[212:215], v[100:103]
    v_accvgpr_read_b32 v226, a70
    s_waitcnt lgkmcnt(5)
    v_mfma_f32_16x16x32_f16 v[48:51], v[136:139], v[228:231], v[48:51]
    ds_read_b128 v[132:135], v8 offset:26112
    v_accvgpr_read_b32 v227, a71
    v_mfma_f32_16x16x32_f16 v[80:83], v[136:139], v[232:235], v[80:83]
    s_waitcnt lgkmcnt(3)
    v_pk_fma_f16 v220, v220, v168, v172
    v_mfma_f32_16x16x32_f16 v[104:107], v[184:187], v[212:215], v[104:107]
    buffer_load_dwordx4 a[92:95], v1, s[40:43], s63 offen offset:3072 sc1
    v_pk_fma_f16 v221, v221, v169, v173
    v_mfma_f32_16x16x32_f16 v[52:55], v[228:231], v[140:143], v[52:55]
    ds_read_b128 v[136:139], v8 offset:27136
    v_mfma_f32_16x16x32_f16 v[84:87], v[232:235], v[140:143], v[84:87]
    v_pk_fma_f16 v222, v222, v170, v174
    v_mfma_f32_16x16x32_f16 v[108:111], v[212:215], v[188:191], v[108:111]
    buffer_load_dwordx4 a[96:99], v5, s[40:43], s56 offen offset:0 sc1
    v_pk_fma_f16 v223, v223, v171, v175
    v_mfma_f32_16x16x32_f16 v[56:59], v[228:231], v[144:147], v[56:59]
    ds_read_b128 v[140:143], v8 offset:28160
    v_pk_fma_f16 v224, v224, v168, v172
    v_mfma_f32_16x16x32_f16 v[88:91], v[232:235], v[144:147], v[88:91]
    v_pk_fma_f16 v225, v225, v169, v173
    v_mfma_f32_16x16x32_f16 v[112:115], v[212:215], v[192:195], v[112:115]
    buffer_load_dwordx4 a[100:103], v5, s[40:43], s60 offen offset:0 sc1
    v_mfma_f32_16x16x32_f16 v[60:63], v[228:231], v[148:151], v[60:63]
    ds_read_b128 v[144:147], v8 offset:29184
    v_pk_fma_f16 v226, v226, v170, v174
    v_mfma_f32_16x16x32_f16 v[92:95], v[232:235], v[148:151], v[92:95]
    v_pk_fma_f16 v227, v227, v171, v175
    v_mfma_f32_16x16x32_f16 v[116:119], v[212:215], v[196:199], v[116:119]
    s_waitcnt vmcnt(6)
    s_waitcnt lgkmcnt(3)
    v_mfma_f32_16x16x32_f16 v[32:35], v[120:123], v[220:223], v[32:35]
    ds_read_b128 v[148:151], v152 offset:30208
    ds_read_b128 v[176:179], v12 offset:32768
    v_mfma_f32_16x16x32_f16 v[64:67], v[120:123], v[224:227], v[64:67]
    ds_read_b128 v[168:171], v167 offset:2432
    buffer_load_dwordx4 a[104:107], v5, s[40:43], s57 offen offset:0 sc1
    v_accvgpr_read_b32 v228, a72
    v_mfma_f32_16x16x32_f16 v[36:39], v[124:127], v[220:223], v[36:39]
    ds_read_b128 v[120:123], v9 offset:23040
    v_accvgpr_read_b32 v229, a73
    v_accvgpr_read_b32 v230, a74
    v_mfma_f32_16x16x32_f16 v[68:71], v[124:127], v[224:227], v[68:71]
    ds_read_b128 v[172:175], v167 offset:2448
    ds_read_b128 v[180:183], v12 offset:34816
    v_mfma_f32_16x16x32_f16 v[40:43], v[128:131], v[220:223], v[40:43]
    ds_read_b128 v[124:127], v9 offset:24064
    v_accvgpr_read_b32 v231, a75
    v_accvgpr_read_b32 v232, a76
    v_mfma_f32_16x16x32_f16 v[72:75], v[128:131], v[224:227], v[72:75]
    ds_read_b128 v[236:239], v6 offset:512
    buffer_load_dwordx4 a[108:111], v5, s[40:43], s61 offen offset:0 sc1
    v_accvgpr_read_b32 v233, a77
    v_mfma_f32_16x16x32_f16 v[44:47], v[132:135], v[220:223], v[44:47]
    ds_read_b128 v[128:131], v9 offset:25088
    ds_read_b128 v[184:187], v12 offset:33792
    v_accvgpr_read_b32 v234, a78
    v_mfma_f32_16x16x32_f16 v[76:79], v[132:135], v[224:227], v[76:79]
    ds_read_b128 v[240:243], v6 offset:528
    v_accvgpr_read_b32 v235, a79
    s_waitcnt lgkmcnt(10)
    v_mfma_f32_16x16x32_f16 v[48:51], v[136:139], v[220:223], v[48:51]
    ds_read_b128 v[132:135], v9 offset:26112
    s_waitcnt lgkmcnt(7)
    v_pk_fma_f16 v228, v228, v168, v172
    v_pk_fma_f16 v229, v229, v169, v173
    v_mfma_f32_16x16x32_f16 v[80:83], v[136:139], v[224:227], v[80:83]
    ds_read_b128 v[188:191], v12 offset:35840
    v_pk_fma_f16 v230, v230, v170, v174
    v_pk_fma_f16 v231, v231, v171, v175
    v_mfma_f32_16x16x32_f16 v[52:55], v[220:223], v[140:143], v[52:55]
    ds_read_b128 v[136:139], v9 offset:27136
    buffer_load_dwordx4 a[112:115], v5, s[40:43], s58 offen offset:0 sc1
    v_pk_fma_f16 v232, v232, v168, v172
    v_mfma_f32_16x16x32_f16 v[84:87], v[224:227], v[140:143], v[84:87]
    v_pk_fma_f16 v233, v233, v169, v173
    v_pk_fma_f16 v234, v234, v170, v174
    v_mfma_f32_16x16x32_f16 v[56:59], v[220:223], v[144:147], v[56:59]
    ds_read_b128 v[140:143], v9 offset:28160
    ds_read_b128 v[192:195], v12 offset:36864
    v_pk_fma_f16 v235, v235, v171, v175
    v_mfma_f32_16x16x32_f16 v[88:91], v[224:227], v[144:147], v[88:91]
    s_waitcnt lgkmcnt(5)
    v_pk_fma_f16 v216, v216, v236, v240
    v_pk_fma_f16 v217, v217, v237, v241
    v_pk_fma_f16 v218, v218, v238, v242
    v_mfma_f32_16x16x32_f16 v[60:63], v[220:223], v[148:151], v[60:63]
    ds_read_b128 v[144:147], v9 offset:29184
    buffer_load_dwordx4 a[116:119], v5, s[40:43], s62 offen offset:0 sc1
    v_pk_fma_f16 v219, v219, v239, v243
    v_mfma_f32_16x16x32_f16 v[92:95], v[224:227], v[148:151], v[92:95]
    ds_read_b128 v[196:199], v156 offset:37888
    s_waitcnt lgkmcnt(6)
    v_mfma_f32_16x16x32_f16 v[32:35], v[120:123], v[228:231], v[32:35]
    ds_read_b128 v[148:151], v153 offset:30208
    s_waitcnt vmcnt(8)
    v_mfma_f32_16x16x32_f16 v[64:67], v[120:123], v[232:235], v[64:67]
    ds_read_b128 v[168:171], v167 offset:4480
    v_accvgpr_read_b32 v236, a80
    v_mfma_f32_16x16x32_f16 v[36:39], v[124:127], v[228:231], v[36:39]
    ds_read_b128 v[120:123], v10 offset:23040
    v_mfma_f32_16x16x32_f16 v[68:71], v[124:127], v[232:235], v[68:71]
    ds_read_b128 v[172:175], v167 offset:4496
    v_accvgpr_read_b32 v237, a81
    v_mfma_f32_16x16x32_f16 v[40:43], v[128:131], v[228:231], v[40:43]
    ds_read_b128 v[124:127], v10 offset:24064
    v_accvgpr_read_b32 v238, a82
    v_mfma_f32_16x16x32_f16 v[72:75], v[128:131], v[232:235], v[72:75]
    v_accvgpr_read_b32 v239, a83
    s_waitcnt lgkmcnt(5)
    v_mfma_f32_16x16x32_f16 v[96:99], v[176:179], v[216:219], v[96:99]
    v_accvgpr_read_b32 v240, a84
    v_mfma_f32_16x16x32_f16 v[44:47], v[132:135], v[228:231], v[44:47]
    ds_read_b128 v[128:131], v10 offset:25088
    v_mfma_f32_16x16x32_f16 v[76:79], v[132:135], v[232:235], v[76:79]
    buffer_load_dwordx4 a[120:123], v5, s[40:43], s59 offen offset:0 sc1
    v_accvgpr_read_b32 v241, a85
    v_mfma_f32_16x16x32_f16 v[100:103], v[180:183], v[216:219], v[100:103]
    v_accvgpr_read_b32 v242, a86
    s_waitcnt lgkmcnt(5)
    v_mfma_f32_16x16x32_f16 v[48:51], v[136:139], v[228:231], v[48:51]
    ds_read_b128 v[132:135], v10 offset:26112
    v_accvgpr_read_b32 v243, a87
    v_mfma_f32_16x16x32_f16 v[80:83], v[136:139], v[232:235], v[80:83]
    s_waitcnt lgkmcnt(3)
    v_pk_fma_f16 v236, v236, v168, v172
    v_mfma_f32_16x16x32_f16 v[104:107], v[184:187], v[216:219], v[104:107]
    v_pk_fma_f16 v237, v237, v169, v173
    v_mfma_f32_16x16x32_f16 v[52:55], v[228:231], v[140:143], v[52:55]
    ds_read_b128 v[136:139], v10 offset:27136
    v_mfma_f32_16x16x32_f16 v[84:87], v[232:235], v[140:143], v[84:87]
    buffer_load_dwordx4 a[124:127], v5, s[40:43], s63 offen offset:0 sc1
    v_pk_fma_f16 v238, v238, v170, v174
    v_mfma_f32_16x16x32_f16 v[108:111], v[216:219], v[188:191], v[108:111]
    v_pk_fma_f16 v239, v239, v171, v175
    v_mfma_f32_16x16x32_f16 v[56:59], v[228:231], v[144:147], v[56:59]
    ds_read_b128 v[140:143], v10 offset:28160
    v_pk_fma_f16 v240, v240, v168, v172
    v_mfma_f32_16x16x32_f16 v[88:91], v[232:235], v[144:147], v[88:91]
    v_pk_fma_f16 v241, v241, v169, v173
    v_mfma_f32_16x16x32_f16 v[112:115], v[216:219], v[192:195], v[112:115]
    v_and_b32 v13, 0x1f0, v1
    v_add_u32 v13, 0x1000, v13
    buffer_load_dwordx4 v[252:255], v13, s[40:43], 0 offen sc1
    v_mfma_f32_16x16x32_f16 v[60:63], v[228:231], v[148:151], v[60:63]
    ds_read_b128 v[144:147], v10 offset:29184
    v_pk_fma_f16 v242, v242, v170, v174
    v_mfma_f32_16x16x32_f16 v[92:95], v[232:235], v[148:151], v[92:95]
    v_pk_fma_f16 v243, v243, v171, v175
    v_mfma_f32_16x16x32_f16 v[116:119], v[216:219], v[196:199], v[116:119]
    s_waitcnt lgkmcnt(3)
    v_mfma_f32_16x16x32_f16 v[32:35], v[120:123], v[236:239], v[32:35]
    ds_read_b128 v[148:151], v154 offset:30208
    s_waitcnt vmcnt(9)
    v_accvgpr_read_b32 v244, a88
    v_mfma_f32_16x16x32_f16 v[64:67], v[120:123], v[240:243], v[64:67]
    ds_read_b128 v[168:171], v167 offset:6528
    s_mov_b32 s86, 0x25400
    buffer_load_dwordx4 v[220:223], v7, s[40:43], s86 offen sc1
    v_mfma_f32_16x16x32_f16 v[36:39], v[124:127], v[236:239], v[36:39]
    ds_read_b128 v[120:123], v11 offset:23040
    v_accvgpr_read_b32 v245, a89
    v_accvgpr_read_b32 v246, a90
    v_mfma_f32_16x16x32_f16 v[68:71], v[124:127], v[240:243], v[68:71]
    ds_read_b128 v[172:175], v167 offset:6544
    ds_write_b128 v4, v[96:99] offset:0
    v_mfma_f32_16x16x32_f16 v[40:43], v[128:131], v[236:239], v[40:43]
    ds_read_b128 v[124:127], v11 offset:24064
    s_mov_b32 s86, 0x29000
    buffer_load_dwordx4 v[224:227], v7, s[40:43], s86 offen sc1
    v_accvgpr_read_b32 v247, a91
    v_mfma_f32_16x16x32_f16 v[72:75], v[128:131], v[240:243], v[72:75]
    v_accvgpr_read_b32 v248, a92
    v_accvgpr_read_b32 v249, a93
    v_accvgpr_read_b32 v250, a94
    v_mfma_f32_16x16x32_f16 v[44:47], v[132:135], v[236:239], v[44:47]
    ds_read_b128 v[128:131], v11 offset:25088
    s_mov_b32 s86, 0x25e00
    buffer_load_dwordx4 v[228:231], v7, s[40:43], s86 offen sc1
    v_mfma_f32_16x16x32_f16 v[76:79], v[132:135], v[240:243], v[76:79]
    ds_write_b128 v4, v[100:103] offset:1024
    v_accvgpr_read_b32 v251, a95
    s_waitcnt lgkmcnt(7)
    v_mfma_f32_16x16x32_f16 v[48:51], v[136:139], v[236:239], v[48:51]
    ds_read_b128 v[132:135], v11 offset:26112
    ds_write_b128 v4, v[104:107] offset:2048
    v_mfma_f32_16x16x32_f16 v[80:83], v[136:139], v[240:243], v[80:83]
    s_lshl2_add_u32 s86, s2, s3
    s_mul_i32 s86, s86, 1920
    v_lshlrev_b32 v14, 7, v0
    s_mov_b64 exec, 0x7fff
    buffer_load_dword v14, v14, s[48:51], s86 offen
    s_mov_b64 exec, -1
    s_waitcnt lgkmcnt(6)
    v_pk_fma_f16 v244, v244, v168, v172
    v_pk_fma_f16 v245, v245, v169, v173
    v_mfma_f32_16x16x32_f16 v[52:55], v[236:239], v[140:143], v[52:55]
    ds_read_b128 v[136:139], v11 offset:27136
    ds_write_b128 v4, v[108:111] offset:3072
    v_pk_fma_f16 v246, v246, v170, v174
    v_mfma_f32_16x16x32_f16 v[84:87], v[240:243], v[140:143], v[84:87]
    ds_write_b128 v4, v[112:115] offset:4096
    v_pk_fma_f16 v247, v247, v171, v175
    v_mfma_f32_16x16x32_f16 v[56:59], v[236:239], v[144:147], v[56:59]
    ds_read_b128 v[140:143], v11 offset:28160
    v_pk_fma_f16 v248, v248, v168, v172
    v_mfma_f32_16x16x32_f16 v[88:91], v[240:243], v[144:147], v[88:91]
    v_pk_fma_f16 v249, v249, v169, v173
    v_pk_fma_f16 v250, v250, v170, v174
    v_mfma_f32_16x16x32_f16 v[60:63], v[236:239], v[148:151], v[60:63]
    ds_read_b128 v[144:147], v11 offset:29184
    v_pk_fma_f16 v251, v251, v171, v175
    v_mfma_f32_16x16x32_f16 v[92:95], v[240:243], v[148:151], v[92:95]
    ds_write_b128 v4, v[116:119] offset:5120
    s_waitcnt lgkmcnt(0)
    s_barrier
    s_mov_b32 s94, 0x8000
    s_waitcnt vmcnt(4)
jchk_23:
    v_xor_b32 v252, s6, v252
    v_xor_b32 v253, s6, v253
    v_xor_b32 v254, s6, v254
    v_xor_b32 v255, s6, v255
    v_or3_b32 v252, v252, v253, v254
    v_or_b32 v252, v252, v255
    v_cmp_ne_u32 vcc, 0, v252
    s_cbranch_vccnz jcold_24
jok_25:
    v_mfma_f32_16x16x32_f16 v[32:35], v[120:123], v[244:247], v[32:35]
    ds_read_b128 v[148:151], v155 offset:30208
    ds_read_b128 v[176:179], v157 offset:0
    v_mfma_f32_16x16x32_f16 v[64:67], v[120:123], v[248:251], v[64:67]
    ds_read_b128 v[168:171], v167 offset:512
    s_mov_b32 s86, 0x29a00
    buffer_load_dwordx4 v[232:235], v7, s[40:43], s86 offen sc1
    v_mfma_f32_16x16x32_f16 v[36:39], v[124:127], v[244:247], v[36:39]
    ds_read_b128 v[120:123], v8 offset:30720
    v_accvgpr_read_b32 v104, a96
    v_accvgpr_read_b32 v105, a97
    v_mfma_f32_16x16x32_f16 v[68:71], v[124:127], v[248:251], v[68:71]
    ds_read_b128 v[172:175], v167 offset:528
    ds_read_b128 v[180:183], v157 offset:6144
    v_accvgpr_read_b32 v106, a98
    v_mfma_f32_16x16x32_f16 v[40:43], v[128:131], v[244:247], v[40:43]
    ds_read_b128 v[124:127], v8 offset:31744
    s_mov_b32 s86, 0x26800
    buffer_load_dwordx4 v[236:239], v7, s[40:43], s86 offen sc1
    v_mfma_f32_16x16x32_f16 v[72:75], v[128:131], v[248:251], v[72:75]
    ds_read_b128 v[184:187], v157 offset:38400
    v_accvgpr_read_b32 v107, a99
    v_accvgpr_read_b32 v108, a100
    v_mfma_f32_16x16x32_f16 v[44:47], v[132:135], v[244:247], v[44:47]
    ds_read_b128 v[128:131], v8 offset:32768
    v_accvgpr_read_b32 v109, a101
    v_accvgpr_read_b32 v110, a102
    v_mfma_f32_16x16x32_f16 v[76:79], v[132:135], v[248:251], v[76:79]
    ds_read_b128 v[188:191], v157 offset:44544
    s_waitcnt lgkmcnt(9)
    v_mfma_f32_16x16x32_f16 v[48:51], v[136:139], v[244:247], v[48:51]
    ds_read_b128 v[132:135], v8 offset:33792
    s_mov_b32 s86, 0x2a400
    buffer_load_dwordx4 v[240:243], v7, s[40:43], s86 offen sc1
    v_accvgpr_read_b32 v111, a103
    v_mfma_f32_16x16x32_f16 v[80:83], v[136:139], v[248:251], v[80:83]
    ds_read_b128 v[192:195], v158 offset:0
    s_waitcnt lgkmcnt(7)
    v_pk_fma_f16 v104, v104, v168, v172
    v_pk_fma_f16 v105, v105, v169, v173
    v_mfma_f32_16x16x32_f16 v[52:55], v[244:247], v[140:143], v[52:55]
    ds_read_b128 v[136:139], v8 offset:34816
    v_pk_fma_f16 v106, v106, v170, v174
    v_mfma_f32_16x16x32_f16 v[84:87], v[248:251], v[140:143], v[84:87]
    buffer_load_dwordx4 a[156:159], v1, s[40:43], s66 offen offset:0 sc1
    ds_read_b128 v[196:199], v158 offset:6144
    v_pk_fma_f16 v107, v107, v171, v175
    v_mfma_f32_16x16x32_f16 v[56:59], v[244:247], v[144:147], v[56:59]
    ds_read_b128 v[140:143], v8 offset:35840
    ds_read_b128 v[200:203], v158 offset:38400
    v_pk_fma_f16 v108, v108, v168, v172
    v_mfma_f32_16x16x32_f16 v[88:91], v[248:251], v[144:147], v[88:91]
    v_pk_fma_f16 v109, v109, v169, v173
    v_pk_fma_f16 v110, v110, v170, v174
    v_mfma_f32_16x16x32_f16 v[60:63], v[244:247], v[148:151], v[60:63]
    ds_read_b128 v[144:147], v8 offset:36864
    buffer_load_dwordx4 a[160:163], v1, s[40:43], s66 offen offset:1024 sc1
    v_pk_fma_f16 v111, v111, v171, v175
    v_mfma_f32_16x16x32_f16 v[92:95], v[248:251], v[148:151], v[92:95]
    ds_read_b128 v[204:207], v158 offset:44544
    s_waitcnt lgkmcnt(0)
    v_mfma_f32_16x16x32_f16 v[32:35], v[120:123], v[104:107], v[32:35]
    ds_read_b128 v[148:151], v152 offset:37888
    v_add_f32 v176, v176, v180
    v_mfma_f32_16x16x32_f16 v[64:67], v[120:123], v[108:111], v[64:67]
    ds_read_b128 v[168:171], v167 offset:2560
    s_mov_b32 s86, 0x27200
    buffer_load_dwordx4 v[244:247], v7, s[40:43], s86 offen sc1
    v_accvgpr_read_b32 v96, a104
    v_mfma_f32_16x16x32_f16 v[36:39], v[124:127], v[104:107], v[36:39]
    ds_read_b128 v[120:123], v9 offset:30720
    v_add_f32 v177, v177, v181
    v_accvgpr_read_b32 v97, a105
    v_accvgpr_read_b32 v98, a106
    v_mfma_f32_16x16x32_f16 v[68:71], v[124:127], v[108:111], v[68:71]
    ds_read_b128 v[172:175], v167 offset:2576
    v_add_f32 v178, v178, v182
    v_accvgpr_read_b32 v99, a107
    v_mfma_f32_16x16x32_f16 v[40:43], v[128:131], v[104:107], v[40:43]
    ds_read_b128 v[124:127], v9 offset:31744
    s_mov_b32 s86, 0x2ae00
    buffer_load_dwordx4 v[248:251], v7, s[40:43], s86 offen sc1
    v_accvgpr_read_b32 v100, a108
    v_mfma_f32_16x16x32_f16 v[72:75], v[128:131], v[108:111], v[72:75]
    v_add_f32 v179, v179, v183
    v_add_f32 v184, v184, v188
    v_accvgpr_read_b32 v101, a109
    v_mfma_f32_16x16x32_f16 v[44:47], v[132:135], v[104:107], v[44:47]
    ds_read_b128 v[128:131], v9 offset:32768
    s_lshl1_add_u32 s83, s4, s30
    s_lshl2_add_u32 s83, s83, s3
    s_mul_i32 s84, s83, 20480
    v_accvgpr_read_b32 v102, a110
    v_mfma_f32_16x16x32_f16 v[76:79], v[132:135], v[108:111], v[76:79]
    v_add_f32 v185, v185, v189
    v_accvgpr_read_b32 v103, a111
    s_waitcnt lgkmcnt(2)
    v_pk_fma_f16 v96, v96, v168, v172
    v_mfma_f32_16x16x32_f16 v[48:51], v[136:139], v[104:107], v[48:51]
    ds_read_b128 v[132:135], v9 offset:33792
    v_add_f32 v186, v186, v190
    v_add_f32 v187, v187, v191
    v_mfma_f32_16x16x32_f16 v[80:83], v[136:139], v[108:111], v[80:83]
    v_lshlrev_b32 v252, 20, v0
    s_mov_b64 exec, 0x7ffff
    buffer_load_dword v253, v252, s[40:43], 0 offen offset:3968 sc1
    s_mov_b64 exec, 7
    buffer_load_dword v254, v252, s[44:47], 0 offen
    s_mov_b64 exec, -1
    v_add_f32 v176, v176, v184
    v_pk_fma_f16 v97, v97, v169, v173
    v_mfma_f32_16x16x32_f16 v[52:55], v[104:107], v[140:143], v[52:55]
    ds_read_b128 v[136:139], v9 offset:34816
    v_add_f32 v177, v177, v185
    v_pk_fma_f16 v98, v98, v170, v174
    v_mfma_f32_16x16x32_f16 v[84:87], v[108:111], v[140:143], v[84:87]
    v_add_f32 v178, v178, v186
    v_add_f32 v179, v179, v187
    v_pk_fma_f16 v99, v99, v171, v175
    v_mfma_f32_16x16x32_f16 v[56:59], v[104:107], v[144:147], v[56:59]
    ds_read_b128 v[140:143], v9 offset:35840
    buffer_load_dwordx4 a[164:167], v1, s[40:43], s66 offen offset:2048 sc1
    v_pk_fma_f16 v100, v100, v168, v172
    v_pk_fma_f16 v101, v101, v169, v173
    v_mfma_f32_16x16x32_f16 v[88:91], v[108:111], v[144:147], v[88:91]
    v_cvt_pk_bf16_f32 v176, v176, v177
    v_cvt_pk_bf16_f32 v177, v178, v179
    v_pk_fma_f16 v102, v102, v170, v174
    v_mfma_f32_16x16x32_f16 v[60:63], v[104:107], v[148:151], v[60:63]
    ds_read_b128 v[144:147], v9 offset:36864
    buffer_load_dwordx4 a[168:171], v1, s[40:43], s66 offen offset:3072 sc1
    v_pk_fma_f16 v103, v103, v171, v175
    v_mfma_f32_16x16x32_f16 v[92:95], v[108:111], v[148:151], v[92:95]
    ds_write_b64 v159, v[176:177]
    s_waitcnt lgkmcnt(4)
    v_mfma_f32_16x16x32_f16 v[32:35], v[120:123], v[96:99], v[32:35]
    ds_read_b128 v[148:151], v153 offset:37888
    v_add_f32 v192, v192, v196
    v_mfma_f32_16x16x32_f16 v[64:67], v[120:123], v[100:103], v[64:67]
    ds_read_b128 v[168:171], v167 offset:4608
    s_mul_i32 s86, s31, 160
    s_add_u32 s84, s84, s86
    v_mul_u32_u24 v6, 1280, v2
    v_lshl_add_u32 v12, v3, 3, v6
    v_accvgpr_read_b32 v104, a112
    v_mfma_f32_16x16x32_f16 v[36:39], v[124:127], v[96:99], v[36:39]
    ds_read_b128 v[120:123], v10 offset:30720
    v_add_f32 v193, v193, v197
    v_accvgpr_read_b32 v105, a113
    v_mfma_f32_16x16x32_f16 v[68:71], v[124:127], v[100:103], v[68:71]
    ds_read_b128 v[172:175], v167 offset:4624
    v_add_f32 v194, v194, v198
    v_accvgpr_read_b32 v106, a114
    v_accvgpr_read_b32 v107, a115
    v_mfma_f32_16x16x32_f16 v[40:43], v[128:131], v[96:99], v[40:43]
    ds_read_b128 v[124:127], v10 offset:31744
    buffer_load_dwordx2 v[208:209], v12, s[32:35], s84 offen offset:0
    v_accvgpr_read_b32 v108, a116
    v_mfma_f32_16x16x32_f16 v[72:75], v[128:131], v[100:103], v[72:75]
    v_add_f32 v195, v195, v199
    v_add_f32 v200, v200, v204
    v_accvgpr_read_b32 v109, a117
    v_mfma_f32_16x16x32_f16 v[44:47], v[132:135], v[96:99], v[44:47]
    ds_read_b128 v[128:131], v10 offset:32768
    v_add_f32 v201, v201, v205
    v_accvgpr_read_b32 v110, a118
    v_mfma_f32_16x16x32_f16 v[76:79], v[132:135], v[100:103], v[76:79]
    v_add_f32 v202, v202, v206
    v_accvgpr_read_b32 v111, a119
    s_waitcnt lgkmcnt(5)
    v_mfma_f32_16x16x32_f16 v[48:51], v[136:139], v[96:99], v[48:51]
    ds_read_b128 v[132:135], v10 offset:33792
    buffer_load_dwordx2 v[210:211], v12, s[32:35], s84 offen offset:32
    s_waitcnt lgkmcnt(3)
    v_pk_fma_f16 v104, v104, v168, v172
    v_mfma_f32_16x16x32_f16 v[80:83], v[136:139], v[100:103], v[80:83]
    v_add_f32 v203, v203, v207
    v_add_f32 v192, v192, v200
    v_pk_fma_f16 v105, v105, v169, v173
    v_mfma_f32_16x16x32_f16 v[52:55], v[96:99], v[140:143], v[52:55]
    ds_read_b128 v[136:139], v10 offset:34816
    v_add_f32 v193, v193, v201
    v_pk_fma_f16 v106, v106, v170, v174
    v_mfma_f32_16x16x32_f16 v[84:87], v[100:103], v[140:143], v[84:87]
    buffer_load_dwordx4 a[172:175], v5, s[40:43], s66 offen offset:0 sc1
    s_add_u32 s66, s66, 40960
    v_add_f32 v194, v194, v202
    v_pk_fma_f16 v107, v107, v171, v175
    v_pk_fma_f16 v108, v108, v168, v172
    v_mfma_f32_16x16x32_f16 v[56:59], v[96:99], v[144:147], v[56:59]
    ds_read_b128 v[140:143], v10 offset:35840
    v_add_f32 v195, v195, v203
    v_pk_fma_f16 v109, v109, v169, v173
    v_mfma_f32_16x16x32_f16 v[88:91], v[100:103], v[144:147], v[88:91]
    v_cvt_pk_bf16_f32 v192, v192, v193
    v_cvt_pk_bf16_f32 v193, v194, v195
    v_pk_fma_f16 v110, v110, v170, v174
    v_mfma_f32_16x16x32_f16 v[60:63], v[96:99], v[148:151], v[60:63]
    ds_read_b128 v[144:147], v10 offset:36864
    buffer_load_dwordx4 a[176:179], v1, s[40:43], s66 offen offset:0 sc1
    v_pk_fma_f16 v111, v111, v171, v175
    v_mfma_f32_16x16x32_f16 v[92:95], v[100:103], v[148:151], v[92:95]
    ds_write_b64 v160, v[192:193]
    s_waitcnt lgkmcnt(4)
    v_mfma_f32_16x16x32_f16 v[32:35], v[120:123], v[104:107], v[32:35]
    ds_read_b128 v[148:151], v154 offset:37888
    v_mfma_f32_16x16x32_f16 v[64:67], v[120:123], v[108:111], v[64:67]
    ds_read_b128 v[168:171], v167 offset:6656
    buffer_load_dwordx2 v[212:213], v12, s[32:35], s84 offen offset:64
    v_mfma_f32_16x16x32_f16 v[36:39], v[124:127], v[104:107], v[36:39]
    ds_read_b128 v[120:123], v11 offset:30720
    v_accvgpr_read_b32 v96, a120
    v_accvgpr_read_b32 v97, a121
    v_mfma_f32_16x16x32_f16 v[68:71], v[124:127], v[108:111], v[68:71]
    ds_read_b128 v[172:175], v167 offset:6672
    v_accvgpr_read_b32 v98, a122
    v_mfma_f32_16x16x32_f16 v[40:43], v[128:131], v[104:107], v[40:43]
    ds_read_b128 v[124:127], v11 offset:31744
    buffer_load_dwordx2 v[214:215], v12, s[32:35], s84 offen offset:96
    v_mfma_f32_16x16x32_f16 v[72:75], v[128:131], v[108:111], v[72:75]
    v_accvgpr_read_b32 v99, a123
    v_accvgpr_read_b32 v100, a124
    v_mfma_f32_16x16x32_f16 v[44:47], v[132:135], v[104:107], v[44:47]
    ds_read_b128 v[128:131], v11 offset:32768
    v_accvgpr_read_b32 v101, a125
    v_mfma_f32_16x16x32_f16 v[76:79], v[132:135], v[108:111], v[76:79]
    v_accvgpr_read_b32 v102, a126
    v_accvgpr_read_b32 v103, a127
    s_waitcnt lgkmcnt(5)
    v_mfma_f32_16x16x32_f16 v[48:51], v[136:139], v[104:107], v[48:51]
    ds_read_b128 v[132:135], v11 offset:33792
    buffer_load_dwordx2 v[216:217], v12, s[32:35], s84 offen offset:128
    v_mfma_f32_16x16x32_f16 v[80:83], v[136:139], v[108:111], v[80:83]
    s_waitcnt lgkmcnt(3)
    v_pk_fma_f16 v96, v96, v168, v172
    v_pk_fma_f16 v97, v97, v169, v173
    v_mfma_f32_16x16x32_f16 v[52:55], v[104:107], v[140:143], v[52:55]
    ds_read_b128 v[136:139], v11 offset:34816
    v_pk_fma_f16 v98, v98, v170, v174
    v_mfma_f32_16x16x32_f16 v[84:87], v[108:111], v[140:143], v[84:87]
    buffer_load_dwordx4 a[180:183], v1, s[40:43], s66 offen offset:1024 sc1
    v_pk_fma_f16 v99, v99, v171, v175
    v_mfma_f32_16x16x32_f16 v[56:59], v[104:107], v[144:147], v[56:59]
    ds_read_b128 v[140:143], v11 offset:35840
    v_pk_fma_f16 v100, v100, v168, v172
    v_pk_fma_f16 v101, v101, v169, v173
    v_mfma_f32_16x16x32_f16 v[88:91], v[108:111], v[144:147], v[88:91]
    v_pk_fma_f16 v102, v102, v170, v174
    v_pk_fma_f16 v103, v103, v171, v175
    v_mfma_f32_16x16x32_f16 v[60:63], v[104:107], v[148:151], v[60:63]
    ds_read_b128 v[144:147], v11 offset:36864
    buffer_load_dwordx4 a[184:187], v1, s[40:43], s66 offen offset:2048 sc1
    v_mfma_f32_16x16x32_f16 v[92:95], v[108:111], v[148:151], v[92:95]
    s_waitcnt lgkmcnt(3)
    v_mfma_f32_16x16x32_f16 v[32:35], v[120:123], v[96:99], v[32:35]
    ds_read_b128 v[148:151], v155 offset:37888
    v_mfma_f32_16x16x32_f16 v[64:67], v[120:123], v[100:103], v[64:67]
    v_mfma_f32_16x16x32_f16 v[36:39], v[124:127], v[96:99], v[36:39]
    v_mfma_f32_16x16x32_f16 v[68:71], v[124:127], v[100:103], v[68:71]
    v_mfma_f32_16x16x32_f16 v[40:43], v[128:131], v[96:99], v[40:43]
    buffer_load_dwordx4 a[188:191], v1, s[40:43], s66 offen offset:3072 sc1
    v_mfma_f32_16x16x32_f16 v[72:75], v[128:131], v[100:103], v[72:75]
    v_mfma_f32_16x16x32_f16 v[44:47], v[132:135], v[96:99], v[44:47]
    v_mfma_f32_16x16x32_f16 v[76:79], v[132:135], v[100:103], v[76:79]
    s_waitcnt lgkmcnt(0)
    v_mfma_f32_16x16x32_f16 v[48:51], v[136:139], v[96:99], v[48:51]
    v_mfma_f32_16x16x32_f16 v[80:83], v[136:139], v[100:103], v[80:83]
    v_mfma_f32_16x16x32_f16 v[52:55], v[96:99], v[140:143], v[52:55]
    v_mfma_f32_16x16x32_f16 v[84:87], v[100:103], v[140:143], v[84:87]
    buffer_load_dwordx4 a[192:195], v5, s[40:43], s66 offen offset:0 sc1
    s_add_u32 s66, s66, 40960
    v_mfma_f32_16x16x32_f16 v[56:59], v[96:99], v[144:147], v[56:59]
    v_mfma_f32_16x16x32_f16 v[88:91], v[100:103], v[144:147], v[88:91]
    v_mfma_f32_16x16x32_f16 v[60:63], v[96:99], v[148:151], v[60:63]
    v_mfma_f32_16x16x32_f16 v[92:95], v[100:103], v[148:151], v[92:95]
    v_lshlrev_b32 v167, 7, v0
    v_cvt_pk_bf16_f32 v108, v72, v73
    v_cvt_pk_bf16_f32 v109, v74, v75
    v_cvt_pk_bf16_f32 v112, v76, v77
    v_cvt_pk_bf16_f32 v113, v78, v79
    v_cvt_pk_bf16_f32 v110, v80, v81
    v_cvt_pk_bf16_f32 v111, v82, v83
    v_cvt_pk_bf16_f32 v150, v80, v81
    v_cvt_pk_bf16_f32 v151, v82, v83
    v_cvt_pk_bf16_f32 v118, v84, v85
    v_cvt_pk_bf16_f32 v119, v86, v87
    v_permlane32_swap_b32 v150, v110
    v_permlane32_swap_b32 v151, v111
    v_cvt_pk_bf16_f32 v124, v88, v89
    v_cvt_pk_bf16_f32 v125, v90, v91
    v_cvt_pk_bf16_f32 v130, v92, v93
    v_cvt_pk_bf16_f32 v131, v94, v95
    ds_write_b64 v161, v[108:109] offset:3072
    ds_write_b64 v161, v[110:111] offset:3584
    ds_write_b64 v161, v[112:113] offset:4096
    ds_write_b64 v161, v[118:119] offset:4608
    ds_write_b64 v161, v[124:125] offset:5120
    ds_write_b64 v161, v[130:131] offset:5632
    buffer_load_dwordx4 a[196:199], v1, s[40:43], s66 offen offset:0 sc1
    buffer_load_dwordx4 a[200:203], v1, s[40:43], s66 offen offset:1024 sc1
    v_cvt_pk_bf16_f32 v102, v40, v41
    v_cvt_pk_bf16_f32 v103, v42, v43
    v_cvt_pk_bf16_f32 v106, v44, v45
    v_cvt_pk_bf16_f32 v107, v46, v47
    v_cvt_pk_bf16_f32 v104, v48, v49
    v_cvt_pk_bf16_f32 v105, v50, v51
    v_cvt_pk_bf16_f32 v148, v48, v49
    v_cvt_pk_bf16_f32 v149, v50, v51
    v_cvt_pk_bf16_f32 v116, v52, v53
    v_cvt_pk_bf16_f32 v117, v54, v55
    v_permlane32_swap_b32 v148, v104
    v_permlane32_swap_b32 v149, v105
    v_cvt_pk_bf16_f32 v122, v56, v57
    v_cvt_pk_bf16_f32 v123, v58, v59
    v_cvt_pk_bf16_f32 v128, v60, v61
    v_cvt_pk_bf16_f32 v129, v62, v63
    s_waitcnt lgkmcnt(0)
    s_barrier
    ds_read_b64 v[96:97], v161 offset:0
    ds_read_b64 v[98:99], v161 offset:512
    ds_read_b64 v[100:101], v161 offset:1024
    ds_read_b64 v[114:115], v161 offset:1536
    ds_read_b64 v[120:121], v161 offset:2048
    ds_read_b64 v[126:127], v161 offset:2560
    buffer_load_dwordx4 a[204:207], v1, s[40:43], s66 offen offset:2048 sc1
    buffer_load_dwordx4 a[208:211], v1, s[40:43], s66 offen offset:3072 sc1
    buffer_load_dwordx4 a[212:215], v5, s[40:43], s66 offen offset:0 sc1
    s_add_u32 s66, s66, 40960
    v_cvt_pk_bf16_f32 v140, v64, v65
    v_cvt_pk_bf16_f32 v141, v66, v67
    v_cvt_pk_bf16_f32 v146, v68, v69
    v_cvt_pk_bf16_f32 v147, v70, v71
    v_cndmask_b32 v142, 0, v150, s[70:71]
    v_cndmask_b32 v144, 0, v150, s[72:73]
    v_cndmask_b32 v143, 0, v151, s[70:71]
    v_cndmask_b32 v145, 0, v151, s[72:73]
    s_nop 0
    v_mfma_f32_16x16x32_bf16 v[192:195], v[102:105], v[140:143], v[20:23]
    v_mfma_f32_16x16x32_bf16 v[196:199], v[108:111], v[140:143], v[16:19]
    v_mfma_f32_16x16x32_bf16 v[200:203], v[104:107], v[144:147], v[20:23]
    v_mfma_f32_16x16x32_bf16 v[204:207], v[110:113], v[144:147], v[16:19]
    v_cvt_pk_bf16_f32 v132, v32, v33
    v_cvt_pk_bf16_f32 v133, v34, v35
    v_cvt_pk_bf16_f32 v138, v36, v37
    v_cvt_pk_bf16_f32 v139, v38, v39
    v_cndmask_b32 v134, 0, v148, s[70:71]
    v_cndmask_b32 v136, 0, v148, s[72:73]
    v_cndmask_b32 v135, 0, v149, s[70:71]
    v_cndmask_b32 v137, 0, v149, s[72:73]
    buffer_load_dwordx4 a[216:219], v1, s[40:43], s66 offen offset:0 sc1
    buffer_load_dwordx4 a[220:223], v1, s[40:43], s66 offen offset:1024 sc1
    v_mfma_f32_16x16x32_bf16 v[180:183], v[102:105], v[132:135], v[16:19]
    v_mfma_f32_16x16x32_bf16 v[188:191], v[104:107], v[136:139], v[16:19]
    s_waitcnt lgkmcnt(3)
    v_mfma_f32_16x16x32_bf16 v[176:179], v[96:99], v[132:135], v[24:27]
    v_mfma_f32_16x16x32_bf16 v[184:187], v[98:101], v[136:139], v[24:27]
    s_mov_b32 s87, 0x3ea52b5c
    v_max3_f32 v84, v192, v193, v196
    v_max3_f32 v85, v194, v195, v198
    v_max_f32 v84, v84, v197
    v_max_f32 v85, v85, v199
    v_max_f32 v90, v84, v85
    buffer_load_dwordx4 a[224:227], v1, s[40:43], s66 offen offset:2048 sc1
    v_max3_f32 v86, v200, v201, v204
    v_max3_f32 v87, v202, v203, v206
    v_max_f32 v86, v86, v205
    v_max_f32 v87, v87, v207
    v_max_f32 v91, v86, v87
    buffer_load_dwordx4 a[228:231], v1, s[40:43], s66 offen offset:3072 sc1
    v_max3_f32 v80, v176, v177, v180
    v_max3_f32 v81, v178, v179, v182
    v_max_f32 v80, v80, v181
    v_max_f32 v81, v81, v183
    v_max_f32 v88, v80, v81
    buffer_load_dwordx4 a[232:235], v5, s[40:43], s66 offen offset:0 sc1
    s_add_u32 s66, s66, 40960
    v_max3_f32 v82, v184, v185, v188
    v_max3_f32 v83, v186, v187, v190
    v_max_f32 v82, v82, v189
    v_max_f32 v83, v83, v191
    v_max_f32 v89, v82, v83
    buffer_load_dwordx4 a[236:239], v1, s[40:43], s66 offen offset:0 sc1
    v_permlane32_swap_b32 v88, v90
    v_permlane32_swap_b32 v89, v91
    buffer_load_dwordx4 a[240:243], v1, s[40:43], s66 offen offset:1024 sc1
    v_max_f32 v88, v88, v90
    v_max_f32 v89, v89, v91
    buffer_load_dwordx4 a[244:247], v1, s[40:43], s66 offen offset:2048 sc1
    s_nop 0
    v_permlane16_swap_b32 v88, v89
    v_max_f32 v88, v88, v89
    v_mul_f32 v89, s87, v88
    v_mul_f32 v90, s87, v88
    v_mul_f32 v91, s87, v88
    v_mul_f32 v88, s87, v88
    buffer_load_dwordx4 a[248:251], v1, s[40:43], s66 offen offset:3072 sc1
    v_permlane16_swap_b32 v90, v91
    v_permlane16_swap_b32 v88, v89
    buffer_load_dwordx4 a[252:255], v5, s[40:43], s66 offen offset:0 sc1
    s_add_u32 s66, s66, 40960
    v_permlane32_swap_b32 v88, v90
    v_permlane32_swap_b32 v89, v91
    v_fma_f32 v80, v80, s87, -v88
    v_fma_f32 v81, v81, s87, -v88
    v_fma_f32 v82, v82, s87, -v89
    v_fma_f32 v83, v83, s87, -v89
    v_fma_f32 v84, v84, s87, -v90
    v_fma_f32 v85, v85, s87, -v90
    v_fma_f32 v86, v86, s87, -v91
    v_fma_f32 v87, v87, s87, -v91
    v_exp_f32 v80, v80
    v_exp_f32 v81, v81
    v_exp_f32 v82, v82
    v_exp_f32 v83, v83
    v_exp_f32 v84, v84
    v_exp_f32 v85, v85
    v_exp_f32 v86, v86
    v_exp_f32 v87, v87
    v_add_f32 v88, v80, v81
    v_add_f32 v89, v82, v83
    v_add_f32 v90, v84, v85
    v_add_f32 v91, v86, v87
    s_nop 0
    v_permlane32_swap_b32 v88, v90
    v_permlane32_swap_b32 v89, v91
    s_add_u32 m0, s68, 0
    s_nop 0
    buffer_load_dwordx4 v164, s[48:51], s67 offen offset:0  lds
    v_add_f32 v88, v88, v90
    v_add_f32 v89, v89, v91
    buffer_load_dwordx4 v165, s[48:51], s67 offen offset:1024  lds
    s_nop 0
    v_permlane16_swap_b32 v88, v89
    v_add_f32 v88, v88, v89
    v_rcp_f32 v89, v88
    v_rcp_f32 v90, v88
    v_rcp_f32 v91, v88
    v_rcp_f32 v88, v88
    buffer_load_dwordx4 v166, s[48:51], s67 offen offset:2048  lds
    s_add_u32 s67, s67, 196608
    v_permlane16_swap_b32 v90, v91
    v_permlane16_swap_b32 v88, v89
    s_add_u32 m0, s68, 12288
    s_nop 0
    buffer_load_dwordx4 v164, s[48:51], s67 offen offset:0  lds
    v_permlane32_swap_b32 v88, v90
    v_permlane32_swap_b32 v89, v91
    s_waitcnt lgkmcnt(0)
    v_mul_f32 v80, v80, v88
    v_mul_f32 v81, v81, v88
    v_cvt_pk_bf16_f32 v80, v80, v80
    v_cvt_pk_bf16_f32 v81, v81, v81
    v_bfi_b32 v64, v28, 0, v80
    v_bfi_b32 v65, v29, 0, v81
    v_bfi_b32 v66, v30, 0, v80
    v_bfi_b32 v67, v31, 0, v81
    v_mul_f32 v82, v82, v89
    v_mul_f32 v83, v83, v89
    v_cvt_pk_bf16_f32 v82, v82, v82
    v_cvt_pk_bf16_f32 v83, v83, v83
    v_bfi_b32 v68, v28, 0, v82
    v_bfi_b32 v69, v29, 0, v83
    v_bfi_b32 v70, v30, 0, v82
    v_bfi_b32 v71, v31, 0, v83
    v_mfma_f32_16x16x32_bf16 v[32:35], v[114:117], v[64:67], 0
    v_mfma_f32_16x16x32_bf16 v[36:39], v[126:129], v[64:67], 0
    v_mul_f32 v84, v84, v90
    v_mul_f32 v85, v85, v90
    v_cvt_pk_bf16_f32 v84, v84, v84
    v_cvt_pk_bf16_f32 v85, v85, v85
    v_bfi_b32 v72, v28, 0, v84
    v_bfi_b32 v73, v29, 0, v85
    v_bfi_b32 v74, v30, 0, v84
    v_bfi_b32 v75, v31, 0, v85
    v_mfma_f32_16x16x32_bf16 v[40:43], v[120:123], v[68:71], 0
    v_mfma_f32_16x16x32_bf16 v[44:47], v[126:129], v[68:71], 0
    v_mul_f32 v86, v86, v91
    v_mul_f32 v87, v87, v91
    v_cvt_pk_bf16_f32 v86, v86, v86
    v_cvt_pk_bf16_f32 v87, v87, v87
    v_bfi_b32 v76, v28, 0, v86
    v_bfi_b32 v77, v29, 0, v87
    v_bfi_b32 v78, v30, 0, v86
    v_bfi_b32 v79, v31, 0, v87
    v_mfma_f32_16x16x32_bf16 v[48:51], v[116:119], v[72:75], 0
    v_mfma_f32_16x16x32_bf16 v[52:55], v[128:131], v[72:75], 0
    v_mfma_f32_16x16x32_bf16 v[56:59], v[122:125], v[76:79], 0
    v_mfma_f32_16x16x32_bf16 v[60:63], v[128:131], v[76:79], 0
    v_cvt_pk_bf16_f32 v176, v32, v33
    v_cvt_pk_bf16_f32 v177, v34, v35
    v_cvt_pk_bf16_f32 v178, v40, v41
    v_cvt_pk_bf16_f32 v179, v42, v43
    v_cvt_pk_bf16_f32 v184, v36, v37
    v_cvt_pk_bf16_f32 v185, v38, v39
    v_cvt_pk_bf16_f32 v188, v44, v45
    v_cvt_pk_bf16_f32 v189, v46, v47
    v_permlane16_swap_b32 v176, v178
    v_permlane16_swap_b32 v177, v179
    v_cndmask_b32 v184, v184, v188, s[72:73]
    v_cndmask_b32 v185, v185, v189, s[72:73]
    v_cvt_pk_bf16_f32 v180, v48, v49
    v_cvt_pk_bf16_f32 v181, v50, v51
    v_cvt_pk_bf16_f32 v182, v56, v57
    v_cvt_pk_bf16_f32 v183, v58, v59
    v_cvt_pk_bf16_f32 v186, v52, v53
    v_cvt_pk_bf16_f32 v187, v54, v55
    v_cvt_pk_bf16_f32 v188, v60, v61
    v_cvt_pk_bf16_f32 v189, v62, v63
    v_permlane16_swap_b32 v180, v182
    v_permlane16_swap_b32 v181, v183
    v_cndmask_b32 v186, v186, v188, s[72:73]
    v_cndmask_b32 v187, v187, v189, s[72:73]
    s_add_u32 s86, s65, 20480
    v_permlane32_swap_b32 v184, v186
    v_permlane32_swap_b32 v185, v187
    buffer_store_dwordx4 v[176:179], v162, s[40:43], s65 offen sc1
    buffer_store_dwordx4 v[180:183], v162, s[40:43], s86 offen sc1
    buffer_store_dwordx2 v[184:185], v163, s[40:43], s65 offen offset:512 sc1
    s_lshl_b32 s86, s7, 7
    s_add_u32 s86, s86, 0x2000
    s_waitcnt vmcnt(0)
    s_waitcnt lgkmcnt(0)
    s_barrier
    s_cmp_lg_u32 s3, 0
    s_cbranch_scc1 pub_26
    v_mov_b32 v14, s6
    s_mov_b32 exec_lo, 1
    s_mov_b32 exec_hi, 0
    buffer_store_dword v14, off, s[40:43], s86 sc1
    s_mov_b64 exec, -1
pub_26:
    s_mov_b32 s94, 0x8000
    s_bfe_u32 s87, s6, 0x80000
    s_bfe_u32 s88, s6, 0x80008
    s_bfe_u32 s89, s6, 0x80010
    s_bfe_u32 s90, s6, 0x80018
mchk_27:
    v_xor_b32 v220, s87, v220
    v_xor_b32 v221, s88, v221
    v_or_b32 v28, v220, v221
    v_xor_b32 v222, s89, v222
    v_xor_b32 v223, s90, v223
    v_or3_b32 v28, v28, v222, v223
    v_xor_b32 v224, s87, v224
    v_xor_b32 v225, s88, v225
    v_or3_b32 v28, v28, v224, v225
    v_xor_b32 v226, s89, v226
    v_xor_b32 v227, s90, v227
    v_or3_b32 v28, v28, v226, v227
    v_xor_b32 v228, s87, v228
    v_xor_b32 v229, s88, v229
    v_or3_b32 v28, v28, v228, v229
    v_xor_b32 v230, s89, v230
    v_xor_b32 v231, s90, v231
    v_or3_b32 v28, v28, v230, v231
    v_xor_b32 v232, s87, v232
    v_xor_b32 v233, s88, v233
    v_or3_b32 v28, v28, v232, v233
    v_xor_b32 v234, s89, v234
    v_xor_b32 v235, s90, v235
    v_or3_b32 v28, v28, v234, v235
    v_xor_b32 v236, s87, v236
    v_xor_b32 v237, s88, v237
    v_or3_b32 v28, v28, v236, v237
    v_xor_b32 v238, s89, v238
    v_xor_b32 v239, s90, v239
    v_or3_b32 v28, v28, v238, v239
    v_xor_b32 v240, s87, v240
    v_xor_b32 v241, s88, v241
    v_or3_b32 v28, v28, v240, v241
    v_xor_b32 v242, s89, v242
    v_xor_b32 v243, s90, v243
    v_or3_b32 v28, v28, v242, v243
    v_xor_b32 v244, s87, v244
    v_xor_b32 v245, s88, v245
    v_or3_b32 v28, v28, v244, v245
    v_xor_b32 v246, s89, v246
    v_xor_b32 v247, s90, v247
    v_or3_b32 v28, v28, v246, v247
    v_xor_b32 v248, s87, v248
    v_xor_b32 v249, s88, v249
    v_or3_b32 v28, v28, v248, v249
    v_xor_b32 v250, s89, v250
    v_xor_b32 v251, s90, v251
    v_or3_b32 v28, v28, v250, v251
    v_cmp_ne_u32_sdwa vcc, v28, v0 src0_sel:BYTE_0 src1_sel:BYTE_3
    s_cbranch_vccnz mcold_28
mok_29:
    v_pk_add_f32 v[220:221], v[220:221], v[224:225]
    v_pk_add_f32 v[222:223], v[222:223], v[226:227]
    v_pk_add_f32 v[228:229], v[228:229], v[232:233]
    v_pk_add_f32 v[230:231], v[230:231], v[234:235]
    v_pk_add_f32 v[236:237], v[236:237], v[240:241]
    v_pk_add_f32 v[238:239], v[238:239], v[242:243]
    v_pk_add_f32 v[244:245], v[244:245], v[248:249]
    v_pk_add_f32 v[246:247], v[246:247], v[250:251]
    v_cvt_pk_bf16_f32 v220, v220, v221
    v_cvt_pk_bf16_f32 v221, v222, v223
    v_cvt_pk_bf16_f32 v228, v228, v229
    v_cvt_pk_bf16_f32 v229, v230, v231
    v_cvt_pk_bf16_f32 v236, v236, v237
    v_cvt_pk_bf16_f32 v237, v238, v239
    v_cvt_pk_bf16_f32 v244, v244, v245
    v_cvt_pk_bf16_f32 v245, v246, v247
    v_lshlrev_b32 v240, 16, v236
    v_and_b32 v241, s96, v236
    v_lshlrev_b32 v242, 16, v237
    v_and_b32 v243, s96, v237
    v_add_f32 v240, 1.0, v240
    v_add_f32 v241, 1.0, v241
    v_add_f32 v242, 1.0, v242
    v_add_f32 v243, 1.0, v243
    v_cvt_pk_bf16_f32 v236, v240, v241
    v_cvt_pk_bf16_f32 v237, v242, v243
    v_lshlrev_b32 v224, 16, v220
    v_and_b32 v225, s96, v220
    v_lshlrev_b32 v226, 16, v221
    v_and_b32 v227, s96, v221
    v_lshlrev_b32 v240, 16, v236
    v_and_b32 v241, s96, v236
    v_lshlrev_b32 v242, 16, v237
    v_and_b32 v243, s96, v237
    v_lshlrev_b32 v248, 16, v244
    v_and_b32 v249, s96, v244
    v_lshlrev_b32 v250, 16, v245
    v_and_b32 v251, s96, v245
    v_add_u32 v12, 153600, v7
    v_lshrrev_b32 v13, 1, v7
    v_add_u32 v13, 153600, v13
    ds_write_b128 v12, v[224:227] offset:0
    ds_write_b128 v12, v[240:243] offset:2560
    ds_write_b128 v12, v[248:251] offset:5120
    ds_write_b64 v13, v[236:237] offset:7680
    ds_write_b64 v13, v[228:229] offset:8960
    v_lshlrev_b32 v144, 16, v208
    v_and_b32 v145, s96, v208
    v_lshlrev_b32 v146, 16, v209
    v_and_b32 v147, s96, v209
    v_lshlrev_b32 v148, 16, v210
    v_and_b32 v149, s96, v210
    v_lshlrev_b32 v150, 16, v211
    v_and_b32 v151, s96, v211
    v_lshlrev_b32 v152, 16, v212
    v_and_b32 v153, s96, v212
    v_lshlrev_b32 v154, 16, v213
    v_and_b32 v155, s96, v213
    v_lshlrev_b32 v156, 16, v214
    v_and_b32 v157, s96, v214
    v_lshlrev_b32 v158, 16, v215
    v_and_b32 v159, s96, v215
    v_lshlrev_b32 v160, 16, v216
    v_and_b32 v161, s96, v216
    v_lshlrev_b32 v162, 16, v217
    v_and_b32 v163, s96, v217
    s_mul_i32 s86, s31, 320
    s_add_u32 s86, s86, 153600
    v_lshl_add_u32 v4, v3, 4, s86
    v_and_b32 v17, 1, v3
    v_lshrrev_b32 v16, 1, v3
    v_lshl_add_u32 v16, v17, 1, v16
    v_lshlrev_b32 v17, 4, v2
    v_lshl_add_u32 v17, v16, 8, v17
    v_lshlrev_b32 v18, 3, v2
    s_mul_i32 s56, s83, 20480
    s_mul_i32 s87, s31, 2560
    s_add_u32 s56, s56, s87
    s_add_u32 s56, s56, 0x5a8000
    s_lshl3_add_u32 s57, s83, s31
    s_lshl_b32 s57, s57, 7
    s_add_u32 s57, s57, 0x40000
    s_waitcnt lgkmcnt(0)
    v_and_b32 v8, 3, v0
    v_lshlrev_b32 v8, 7, v8
    s_lshl2_add_u32 s86, s4, s3
    s_lshl_b32 s86, s86, 9
    s_add_u32 s86, s86, 0x2000
    s_lshl1_add_u32 s87, s4, s30
    s_mul_i32 s87, s87, 81920
    s_mul_i32 s92, s3, 5120
    s_add_u32 s87, s87, s92
    s_add_u32 s87, s87, 0x328000
    s_xor_b32 s92, s3, 0
    s_mul_i32 s88, s92, 20480
    s_add_u32 s88, s88, s87
    s_xor_b32 s92, s3, 1
    s_mul_i32 s89, s92, 20480
    s_add_u32 s89, s89, s87
    s_mul_i32 s92, s92, 15360
    s_add_u32 s92, s92, 92160
    v_add_u32 v9, s92, v1
    s_xor_b32 s92, s3, 2
    s_mul_i32 s90, s92, 20480
    s_add_u32 s90, s90, s87
    s_mul_i32 s92, s92, 15360
    s_add_u32 s92, s92, 97280
    v_add_u32 v10, s92, v1
    s_xor_b32 s92, s3, 3
    s_mul_i32 s91, s92, 20480
    s_add_u32 s91, s91, s87
    s_mul_i32 s92, s92, 15360
    s_add_u32 s92, s92, 102400
    v_add_u32 v11, s92, v1
    s_mul_i32 s92, s3, 15360
    s_add_u32 s92, s92, 92160
    v_add_u32 v12, s92, v1
    s_mov_b32 s94, 0x8000
poll_30:
    buffer_load_dword v13, v8, s[40:43], s86 offen sc1
    s_waitcnt vmcnt(0)
    v_cmp_ne_u32 vcc, s6, v13
    s_cbranch_vccz pdone_31
    s_sub_u32 s94, s94, 1
    s_cmp_lg_u32 s94, 0
    s_cbranch_scc1 poll_30
pdone_31:
    buffer_load_dwordx4 v[32:35], v1, s[40:43], s89 offen offset:0 sc1
    buffer_load_dwordx4 v[36:39], v1, s[40:43], s89 offen offset:1024 sc1
    buffer_load_dwordx4 v[40:43], v1, s[40:43], s89 offen offset:2048 sc1
    buffer_load_dwordx4 v[44:47], v1, s[40:43], s89 offen offset:3072 sc1
    buffer_load_dwordx4 v[48:51], v5, s[40:43], s89 offen offset:0 sc1
    buffer_load_dwordx4 v[52:55], v1, s[40:43], s90 offen offset:0 sc1
    buffer_load_dwordx4 v[56:59], v1, s[40:43], s90 offen offset:1024 sc1
    buffer_load_dwordx4 v[60:63], v1, s[40:43], s90 offen offset:2048 sc1
    buffer_load_dwordx4 v[64:67], v1, s[40:43], s90 offen offset:3072 sc1
    buffer_load_dwordx4 v[68:71], v5, s[40:43], s90 offen offset:0 sc1
    buffer_load_dwordx4 v[72:75], v1, s[40:43], s91 offen offset:0 sc1
    buffer_load_dwordx4 v[76:79], v1, s[40:43], s91 offen offset:1024 sc1
    s_waitcnt vmcnt(11)
    v_mfma_f32_16x16x32_bf16 v[196:199], a[156:159], v[32:35], 0
    buffer_load_dwordx4 v[80:83], v1, s[40:43], s91 offen offset:2048 sc1
    v_mfma_f32_16x16x32_bf16 v[200:203], a[160:163], v[32:35], 0
    v_mfma_f32_16x16x32_bf16 v[204:207], a[164:167], v[32:35], 0
    v_mfma_f32_16x16x32_bf16 v[208:211], a[168:171], v[32:35], 0
    v_mfma_f32_16x16x32_bf16 v[212:215], a[172:175], v[32:35], 0
    s_waitcnt vmcnt(11)
    v_mfma_f32_16x16x32_bf16 v[196:199], a[176:179], v[36:39], v[196:199]
    buffer_load_dwordx4 v[84:87], v1, s[40:43], s91 offen offset:3072 sc1
    v_mfma_f32_16x16x32_bf16 v[200:203], a[180:183], v[36:39], v[200:203]
    v_mfma_f32_16x16x32_bf16 v[204:207], a[184:187], v[36:39], v[204:207]
    v_mfma_f32_16x16x32_bf16 v[208:211], a[188:191], v[36:39], v[208:211]
    v_mfma_f32_16x16x32_bf16 v[212:215], a[192:195], v[36:39], v[212:215]
    s_waitcnt vmcnt(11)
    v_mfma_f32_16x16x32_bf16 v[196:199], a[196:199], v[40:43], v[196:199]
    buffer_load_dwordx4 v[88:91], v5, s[40:43], s91 offen offset:0 sc1
    v_mfma_f32_16x16x32_bf16 v[200:203], a[200:203], v[40:43], v[200:203]
    v_mfma_f32_16x16x32_bf16 v[204:207], a[204:207], v[40:43], v[204:207]
    v_mfma_f32_16x16x32_bf16 v[208:211], a[208:211], v[40:43], v[208:211]
    v_mfma_f32_16x16x32_bf16 v[212:215], a[212:215], v[40:43], v[212:215]
    s_waitcnt vmcnt(11)
    v_mfma_f32_16x16x32_bf16 v[196:199], a[216:219], v[44:47], v[196:199]
    buffer_load_dwordx4 v[32:35], v1, s[40:43], s88 offen offset:0 sc1
    v_mfma_f32_16x16x32_bf16 v[200:203], a[220:223], v[44:47], v[200:203]
    v_mfma_f32_16x16x32_bf16 v[204:207], a[224:227], v[44:47], v[204:207]
    v_mfma_f32_16x16x32_bf16 v[208:211], a[228:231], v[44:47], v[208:211]
    v_mfma_f32_16x16x32_bf16 v[212:215], a[232:235], v[44:47], v[212:215]
    s_waitcnt vmcnt(11)
    v_mfma_f32_16x16x32_bf16 v[196:199], a[236:239], v[48:51], v[196:199]
    buffer_load_dwordx4 v[36:39], v1, s[40:43], s88 offen offset:1024 sc1
    v_mfma_f32_16x16x32_bf16 v[200:203], a[240:243], v[48:51], v[200:203]
    s_barrier
    v_mfma_f32_16x16x32_bf16 v[204:207], a[244:247], v[48:51], v[204:207]
    v_mfma_f32_16x16x32_bf16 v[208:211], a[248:251], v[48:51], v[208:211]
    v_mfma_f32_16x16x32_bf16 v[212:215], a[252:255], v[48:51], v[212:215]
    s_waitcnt vmcnt(11)
    v_mfma_f32_16x16x32_bf16 v[216:219], a[156:159], v[52:55], 0
    buffer_load_dwordx4 v[40:43], v1, s[40:43], s88 offen offset:2048 sc1
    v_mfma_f32_16x16x32_bf16 v[220:223], a[160:163], v[52:55], 0
    ds_read_b128 v[92:95], v4 offset:0
    v_mfma_f32_16x16x32_bf16 v[224:227], a[164:167], v[52:55], 0
    ds_read_b128 v[96:99], v4 offset:64
    v_mfma_f32_16x16x32_bf16 v[228:231], a[168:171], v[52:55], 0
    ds_read_b128 v[100:103], v4 offset:128
    v_mfma_f32_16x16x32_bf16 v[232:235], a[172:175], v[52:55], 0
    s_waitcnt vmcnt(11)
    v_mfma_f32_16x16x32_bf16 v[216:219], a[176:179], v[56:59], v[216:219]
    buffer_load_dwordx4 v[44:47], v1, s[40:43], s88 offen offset:3072 sc1
    v_mfma_f32_16x16x32_bf16 v[220:223], a[180:183], v[56:59], v[220:223]
    ds_write_b128 v9, v[196:199] offset:0
    v_mfma_f32_16x16x32_bf16 v[224:227], a[184:187], v[56:59], v[224:227]
    v_mfma_f32_16x16x32_bf16 v[228:231], a[188:191], v[56:59], v[228:231]
    ds_write_b128 v9, v[200:203] offset:1024
    v_mfma_f32_16x16x32_bf16 v[232:235], a[192:195], v[56:59], v[232:235]
    s_waitcnt vmcnt(11)
    v_mfma_f32_16x16x32_bf16 v[216:219], a[196:199], v[60:63], v[216:219]
    buffer_load_dwordx4 v[48:51], v5, s[40:43], s88 offen offset:0 sc1
    v_mfma_f32_16x16x32_bf16 v[220:223], a[200:203], v[60:63], v[220:223]
    ds_write_b128 v9, v[204:207] offset:2048
    v_mfma_f32_16x16x32_bf16 v[224:227], a[204:207], v[60:63], v[224:227]
    v_mfma_f32_16x16x32_bf16 v[228:231], a[208:211], v[60:63], v[228:231]
    ds_write_b128 v9, v[208:211] offset:3072
    v_mfma_f32_16x16x32_bf16 v[232:235], a[212:215], v[60:63], v[232:235]
    s_waitcnt vmcnt(11)
    v_mfma_f32_16x16x32_bf16 v[216:219], a[216:219], v[64:67], v[216:219]
    buffer_load_dwordx4 v165, s[48:51], s67 offen offset:1024  lds
    v_mfma_f32_16x16x32_bf16 v[220:223], a[220:223], v[64:67], v[220:223]
    ds_write_b128 v9, v[212:215] offset:4096
    v_mfma_f32_16x16x32_bf16 v[224:227], a[224:227], v[64:67], v[224:227]
    buffer_load_dwordx4 v166, s[48:51], s67 offen offset:2048  lds
    s_add_u32 s67, s67, 196608
    v_mfma_f32_16x16x32_bf16 v[228:231], a[228:231], v[64:67], v[228:231]
    v_mfma_f32_16x16x32_bf16 v[232:235], a[232:235], v[64:67], v[232:235]
    s_waitcnt vmcnt(12)
    v_mfma_f32_16x16x32_bf16 v[216:219], a[236:239], v[68:71], v[216:219]
    s_add_u32 m0, s68, 24576
    s_nop 0
    buffer_load_dwordx4 v164, s[48:51], s67 offen offset:0  lds
    v_mfma_f32_16x16x32_bf16 v[220:223], a[240:243], v[68:71], v[220:223]
    ds_read_b128 v[124:127], v4 offset:2752
    v_mfma_f32_16x16x32_bf16 v[224:227], a[244:247], v[68:71], v[224:227]
    buffer_load_dwordx4 v165, s[48:51], s67 offen offset:1024  lds
    v_mfma_f32_16x16x32_bf16 v[228:231], a[248:251], v[68:71], v[228:231]
    ds_read_b128 v[128:131], v4 offset:2816
    v_mfma_f32_16x16x32_bf16 v[232:235], a[252:255], v[68:71], v[232:235]
    s_waitcnt vmcnt(13)
    v_mfma_f32_16x16x32_bf16 v[236:239], a[156:159], v[72:75], 0
    buffer_load_dwordx4 v166, s[48:51], s67 offen offset:2048  lds
    s_add_u32 s67, s67, 196608
    v_mfma_f32_16x16x32_bf16 v[240:243], a[160:163], v[72:75], 0
    ds_read_b128 v[104:107], v4 offset:192
    v_mfma_f32_16x16x32_bf16 v[244:247], a[164:167], v[72:75], 0
    s_add_u32 m0, s68, 36864
    s_nop 0
    buffer_load_dwordx4 v164, s[48:51], s67 offen offset:0  lds
    v_mfma_f32_16x16x32_bf16 v[248:251], a[168:171], v[72:75], 0
    ds_read_b128 v[108:111], v4 offset:256
    v_mfma_f32_16x16x32_bf16 v[252:255], a[172:175], v[72:75], 0
    ds_read_b128 v[112:115], v4 offset:2560
    s_waitcnt vmcnt(14)
    v_mfma_f32_16x16x32_bf16 v[236:239], a[176:179], v[76:79], v[236:239]
    buffer_load_dwordx4 v165, s[48:51], s67 offen offset:1024  lds
    v_mfma_f32_16x16x32_bf16 v[240:243], a[180:183], v[76:79], v[240:243]
    ds_write_b128 v10, v[216:219] offset:0
    v_mfma_f32_16x16x32_bf16 v[244:247], a[184:187], v[76:79], v[244:247]
    buffer_load_dwordx4 v166, s[48:51], s67 offen offset:2048  lds
    s_add_u32 s67, s67, 196608
    v_mfma_f32_16x16x32_bf16 v[248:251], a[188:191], v[76:79], v[248:251]
    ds_write_b128 v10, v[220:223] offset:1024
    v_mfma_f32_16x16x32_bf16 v[252:255], a[192:195], v[76:79], v[252:255]
    s_waitcnt vmcnt(15)
    v_mfma_f32_16x16x32_bf16 v[236:239], a[196:199], v[80:83], v[236:239]
    s_add_u32 m0, s68, 49152
    s_nop 0
    buffer_load_dwordx4 v164, s[48:51], s67 offen offset:0  lds
    v_mfma_f32_16x16x32_bf16 v[240:243], a[200:203], v[80:83], v[240:243]
    ds_write_b128 v10, v[224:227] offset:2048
    v_mfma_f32_16x16x32_bf16 v[244:247], a[204:207], v[80:83], v[244:247]
    buffer_load_dwordx4 v165, s[48:51], s67 offen offset:1024  lds
    v_mfma_f32_16x16x32_bf16 v[248:251], a[208:211], v[80:83], v[248:251]
    ds_write_b128 v10, v[228:231] offset:3072
    v_mfma_f32_16x16x32_bf16 v[252:255], a[212:215], v[80:83], v[252:255]
    s_waitcnt vmcnt(16)
    v_mfma_f32_16x16x32_bf16 v[236:239], a[216:219], v[84:87], v[236:239]
    v_mfma_f32_16x16x32_bf16 v[240:243], a[220:223], v[84:87], v[240:243]
    ds_write_b128 v10, v[232:235] offset:4096
    v_mfma_f32_16x16x32_bf16 v[244:247], a[224:227], v[84:87], v[244:247]
    v_mfma_f32_16x16x32_bf16 v[248:251], a[228:231], v[84:87], v[248:251]
    v_mfma_f32_16x16x32_bf16 v[252:255], a[232:235], v[84:87], v[252:255]
    s_waitcnt vmcnt(15)
    v_mfma_f32_16x16x32_bf16 v[236:239], a[236:239], v[88:91], v[236:239]
    v_mfma_f32_16x16x32_bf16 v[240:243], a[240:243], v[88:91], v[240:243]
    v_mfma_f32_16x16x32_bf16 v[244:247], a[244:247], v[88:91], v[244:247]
    v_mfma_f32_16x16x32_bf16 v[248:251], a[248:251], v[88:91], v[248:251]
    v_mfma_f32_16x16x32_bf16 v[252:255], a[252:255], v[88:91], v[252:255]
    s_waitcnt vmcnt(14)
    v_mfma_f32_16x16x32_bf16 v[176:179], a[156:159], v[32:35], 0
    v_mfma_f32_16x16x32_bf16 v[180:183], a[160:163], v[32:35], 0
    ds_read_b128 v[116:119], v4 offset:2624
    v_mfma_f32_16x16x32_bf16 v[184:187], a[164:167], v[32:35], 0
    ds_read_b128 v[120:123], v4 offset:2688
    v_mfma_f32_16x16x32_bf16 v[188:191], a[168:171], v[32:35], 0
    v_mfma_f32_16x16x32_bf16 v[192:195], a[172:175], v[32:35], 0
    s_waitcnt vmcnt(13)
    v_mfma_f32_16x16x32_bf16 v[176:179], a[176:179], v[36:39], v[176:179]
    v_mfma_f32_16x16x32_bf16 v[180:183], a[180:183], v[36:39], v[180:183]
    ds_write_b128 v11, v[236:239] offset:0
    v_mfma_f32_16x16x32_bf16 v[184:187], a[184:187], v[36:39], v[184:187]
    v_mfma_f32_16x16x32_bf16 v[188:191], a[188:191], v[36:39], v[188:191]
    ds_write_b128 v11, v[240:243] offset:1024
    v_mfma_f32_16x16x32_bf16 v[192:195], a[192:195], v[36:39], v[192:195]
    s_waitcnt vmcnt(12)
    v_mfma_f32_16x16x32_bf16 v[176:179], a[196:199], v[40:43], v[176:179]
    v_mfma_f32_16x16x32_bf16 v[180:183], a[200:203], v[40:43], v[180:183]
    ds_write_b128 v11, v[244:247] offset:2048
    v_mfma_f32_16x16x32_bf16 v[184:187], a[204:207], v[40:43], v[184:187]
    v_mfma_f32_16x16x32_bf16 v[188:191], a[208:211], v[40:43], v[188:191]
    ds_write_b128 v11, v[248:251] offset:3072
    v_mfma_f32_16x16x32_bf16 v[192:195], a[212:215], v[40:43], v[192:195]
    s_waitcnt vmcnt(11)
    v_mfma_f32_16x16x32_bf16 v[176:179], a[216:219], v[44:47], v[176:179]
    v_mfma_f32_16x16x32_bf16 v[180:183], a[220:223], v[44:47], v[180:183]
    ds_write_b128 v11, v[252:255] offset:4096
    v_mfma_f32_16x16x32_bf16 v[184:187], a[224:227], v[44:47], v[184:187]
    v_mfma_f32_16x16x32_bf16 v[188:191], a[228:231], v[44:47], v[188:191]
    v_mfma_f32_16x16x32_bf16 v[192:195], a[232:235], v[44:47], v[192:195]
    s_waitcnt lgkmcnt(0)
    s_barrier
    s_waitcnt vmcnt(10)
    v_mfma_f32_16x16x32_bf16 v[176:179], a[236:239], v[48:51], v[176:179]
    v_mfma_f32_16x16x32_bf16 v[180:183], a[240:243], v[48:51], v[180:183]
    ds_read_b128 v[196:199], v12 offset:0
    v_mfma_f32_16x16x32_bf16 v[184:187], a[244:247], v[48:51], v[184:187]
    ds_read_b128 v[200:203], v12 offset:1024
    v_mfma_f32_16x16x32_bf16 v[188:191], a[248:251], v[48:51], v[188:191]
    ds_read_b128 v[204:207], v12 offset:2048
    v_mfma_f32_16x16x32_bf16 v[192:195], a[252:255], v[48:51], v[192:195]
    ds_read_b128 v[208:211], v12 offset:3072
    ds_read_b128 v[212:215], v12 offset:4096
    ds_read_b128 v[216:219], v12 offset:5120
    ds_read_b128 v[220:223], v12 offset:6144
    ds_read_b128 v[224:227], v12 offset:7168
    ds_read_b128 v[228:231], v12 offset:8192
    ds_read_b128 v[232:235], v12 offset:9216
    ds_read_b128 v[236:239], v12 offset:10240
    ds_read_b128 v[240:243], v12 offset:11264
    ds_read_b128 v[244:247], v12 offset:12288
    ds_read_b128 v[248:251], v12 offset:13312
    ds_read_b128 v[252:255], v12 offset:14336
    buffer_load_dwordx4 v166, s[48:51], s67 offen offset:2048  lds
    s_add_u32 s67, s67, 196608
    s_add_u32 m0, s68, 61440
    s_nop 0
    buffer_load_dwordx4 v164, s[48:51], s67 offen offset:0  lds
    buffer_load_dwordx4 v165, s[48:51], s67 offen offset:1024  lds
    buffer_load_dwordx4 v166, s[48:51], s67 offen offset:2048  lds
    s_add_u32 s67, s67, 196608
    s_add_u32 m0, s68, 73728
    s_nop 0
    buffer_load_dwordx4 v164, s[48:51], s67 offen offset:0  lds
    buffer_load_dwordx4 v165, s[48:51], s67 offen offset:1024  lds
    buffer_load_dwordx4 v166, s[48:51], s67 offen offset:2048  lds
    s_add_u32 s67, s67, 196608
    s_waitcnt lgkmcnt(5)
    v_pk_add_f32 v[196:197], v[196:197], v[216:217]
    v_pk_add_f32 v[198:199], v[198:199], v[218:219]
    v_pk_add_f32 v[200:201], v[200:201], v[220:221]
    v_pk_add_f32 v[202:203], v[202:203], v[222:223]
    v_pk_add_f32 v[204:205], v[204:205], v[224:225]
    v_pk_add_f32 v[206:207], v[206:207], v[226:227]
    v_pk_add_f32 v[208:209], v[208:209], v[228:229]
    v_pk_add_f32 v[210:211], v[210:211], v[230:231]
    v_pk_add_f32 v[212:213], v[212:213], v[232:233]
    v_pk_add_f32 v[214:215], v[214:215], v[234:235]
    s_waitcnt lgkmcnt(0)
    v_pk_add_f32 v[176:177], v[176:177], v[236:237]
    v_pk_add_f32 v[178:179], v[178:179], v[238:239]
    v_pk_add_f32 v[180:181], v[180:181], v[240:241]
    v_pk_add_f32 v[182:183], v[182:183], v[242:243]
    v_pk_add_f32 v[184:185], v[184:185], v[244:245]
    v_pk_add_f32 v[186:187], v[186:187], v[246:247]
    v_pk_add_f32 v[188:189], v[188:189], v[248:249]
    v_pk_add_f32 v[190:191], v[190:191], v[250:251]
    v_pk_add_f32 v[192:193], v[192:193], v[252:253]
    v_pk_add_f32 v[194:195], v[194:195], v[254:255]
    v_pk_add_f32 v[176:177], v[176:177], v[196:197]
    v_pk_add_f32 v[178:179], v[178:179], v[198:199]
    v_pk_add_f32 v[180:181], v[180:181], v[200:201]
    v_pk_add_f32 v[182:183], v[182:183], v[202:203]
    v_pk_add_f32 v[184:185], v[184:185], v[204:205]
    v_pk_add_f32 v[186:187], v[186:187], v[206:207]
    v_pk_add_f32 v[188:189], v[188:189], v[208:209]
    v_pk_add_f32 v[190:191], v[190:191], v[210:211]
    v_pk_add_f32 v[192:193], v[192:193], v[212:213]
    v_pk_add_f32 v[194:195], v[194:195], v[214:215]
    v_pk_fma_f32 v[144:145], v[176:177], v[92:93], v[144:145]
    v_pk_fma_f32 v[146:147], v[178:179], v[94:95], v[146:147]
    v_pk_fma_f32 v[148:149], v[180:181], v[96:97], v[148:149]
    v_pk_fma_f32 v[150:151], v[182:183], v[98:99], v[150:151]
    v_pk_fma_f32 v[152:153], v[184:185], v[100:101], v[152:153]
    v_pk_fma_f32 v[154:155], v[186:187], v[102:103], v[154:155]
    v_pk_fma_f32 v[156:157], v[188:189], v[104:105], v[156:157]
    v_pk_fma_f32 v[158:159], v[190:191], v[106:107], v[158:159]
    v_pk_fma_f32 v[160:161], v[192:193], v[108:109], v[160:161]
    v_pk_fma_f32 v[162:163], v[194:195], v[110:111], v[162:163]
    v_pk_mul_f32 v[112:113], v[112:113], v[144:145]
    v_pk_mul_f32 v[114:115], v[114:115], v[146:147]
    v_pk_mul_f32 v[116:117], v[116:117], v[148:149]
    v_pk_mul_f32 v[118:119], v[118:119], v[150:151]
    v_pk_mul_f32 v[120:121], v[120:121], v[152:153]
    v_pk_mul_f32 v[122:123], v[122:123], v[154:155]
    v_pk_mul_f32 v[124:125], v[124:125], v[156:157]
    v_pk_mul_f32 v[126:127], v[126:127], v[158:159]
    v_pk_mul_f32 v[128:129], v[128:129], v[160:161]
    v_pk_mul_f32 v[130:131], v[130:131], v[162:163]
    v_cvt_pk_bf16_f32 v20, v112, v113
    v_cvt_pk_bf16_f32 v21, v114, v115
    v_cvt_pk_bf16_f32 v22, v116, v117
    v_cvt_pk_bf16_f32 v23, v118, v119
    v_cvt_pk_bf16_f32 v24, v120, v121
    v_cvt_pk_bf16_f32 v25, v122, v123
    v_cvt_pk_bf16_f32 v26, v124, v125
    v_cvt_pk_bf16_f32 v27, v126, v127
    v_cvt_pk_bf16_f32 v28, v128, v129
    v_cvt_pk_bf16_f32 v29, v130, v131
    v_mov_b32 v30, v28
    v_mov_b32 v31, v29
    v_permlane16_swap_b32 v20, v22
    v_permlane16_swap_b32 v21, v23
    v_permlane16_swap_b32 v24, v26
    v_permlane16_swap_b32 v25, v27
    v_permlane16_swap_b32 v28, v30
    v_permlane16_swap_b32 v29, v31
    buffer_store_dwordx4 v[20:23], v17, s[40:43], s56 offen offset:0 sc1
    buffer_store_dwordx4 v[24:27], v17, s[40:43], s56 offen offset:1024 sc1
    s_mov_b32 exec_lo, 0xffff
    s_mov_b32 exec_hi, 0xffff
    buffer_store_dwordx4 v[28:31], v17, s[40:43], s56 offen offset:2048 sc1
    s_mov_b64 exec, -1
    v_pk_add_f32 v[32:33], v[144:145], v[146:147]
    v_pk_mul_f32 v[34:35], v[144:145], v[144:145]
    v_pk_fma_f32 v[34:35], v[146:147], v[146:147], v[34:35]
    v_pk_add_f32 v[32:33], v[32:33], v[148:149]
    v_pk_fma_f32 v[34:35], v[148:149], v[148:149], v[34:35]
    v_pk_add_f32 v[32:33], v[32:33], v[150:151]
    v_pk_fma_f32 v[34:35], v[150:151], v[150:151], v[34:35]
    v_pk_add_f32 v[32:33], v[32:33], v[152:153]
    v_pk_fma_f32 v[34:35], v[152:153], v[152:153], v[34:35]
    v_pk_add_f32 v[32:33], v[32:33], v[154:155]
    v_pk_fma_f32 v[34:35], v[154:155], v[154:155], v[34:35]
    v_pk_add_f32 v[32:33], v[32:33], v[156:157]
    v_pk_fma_f32 v[34:35], v[156:157], v[156:157], v[34:35]
    v_pk_add_f32 v[32:33], v[32:33], v[158:159]
    v_pk_fma_f32 v[34:35], v[158:159], v[158:159], v[34:35]
    v_pk_add_f32 v[32:33], v[32:33], v[160:161]
    v_pk_fma_f32 v[34:35], v[160:161], v[160:161], v[34:35]
    v_pk_add_f32 v[32:33], v[32:33], v[162:163]
    v_pk_fma_f32 v[34:35], v[162:163], v[162:163], v[34:35]
    v_add_f32 v32, v32, v33
    v_add_f32 v33, v34, v35
    v_mov_b32 v34, v32
    v_mov_b32 v35, v33
    s_nop 0
    v_permlane32_swap_b32 v32, v34
    v_permlane32_swap_b32 v33, v35
    v_add_f32 v32, v32, v34
    v_add_f32 v33, v33, v35
    v_mov_b32 v34, v32
    v_mov_b32 v35, v33
    s_nop 0
    v_permlane16_swap_b32 v32, v34
    v_permlane16_swap_b32 v33, v35
    v_add_f32 v32, v32, v34
    v_add_f32 v33, v33, v35
    s_mov_b64 exec, 0xffff
    buffer_store_dwordx2 v[32:33], v18, s[40:43], s57 offen sc1
    s_mov_b64 exec, -1
    s_lshl_b32 s86, s7, 7
    s_add_u32 s86, s86, 0xa000
    s_waitcnt vmcnt(0)
    s_waitcnt lgkmcnt(0)
    s_barrier
    s_cmp_lg_u32 s3, 0
    s_cbranch_scc1 pub_32
    v_mov_b32 v14, s6
    s_mov_b32 exec_lo, 1
    s_mov_b32 exec_hi, 0
    buffer_store_dword v14, off, s[40:43], s86 sc1
    s_mov_b64 exec, -1
pub_32:
    s_add_u32 m0, s68, 86016
    s_nop 0
    buffer_load_dwordx4 v164, s[48:51], s67 offen offset:0  lds
    buffer_load_dwordx4 v165, s[48:51], s67 offen offset:1024  lds
    buffer_load_dwordx4 v166, s[48:51], s67 offen offset:2048  lds
    s_add_u32 s67, s67, 196608
    s_add_u32 m0, s68, 98304
    s_nop 0
    buffer_load_dwordx4 v164, s[48:51], s67 offen offset:0  lds
    buffer_load_dwordx4 v165, s[48:51], s67 offen offset:1024  lds
    buffer_load_dwordx4 v166, s[48:51], s67 offen offset:2048  lds
    s_add_u32 s67, s67, 196608
    s_add_u32 m0, s68, 110592
    s_nop 0
    buffer_load_dwordx4 v164, s[48:51], s67 offen offset:0  lds
    buffer_load_dwordx4 v165, s[48:51], s67 offen offset:1024  lds
    buffer_load_dwordx4 v166, s[48:51], s67 offen offset:2048  lds
    s_add_u32 s67, s67, 196608
    s_mul_i32 s86, s3, 5120
    s_add_u32 s86, s86, 122880
    v_add_u32 v7, s86, v1
    ds_write_b128 v7, v[144:147] offset:0
    ds_write_b128 v7, v[148:151] offset:1024
    ds_write_b128 v7, v[152:155] offset:2048
    ds_write_b128 v7, v[156:159] offset:3072
    ds_write_b128 v7, v[160:163] offset:4096
    s_cmp_eq_u32 s3, 3
    s_cselect_b32 s58, 0, s3
    s_add_u32 s59, s58, 1
    s_cmp_eq_u32 s59, 3
    s_cselect_b32 s59, 0, s59
    s_add_u32 s60, s59, 1
    s_cmp_eq_u32 s60, 3
    s_cselect_b32 s60, 0, s60
    v_bfe_u32 v16, v0, 2, 2
    v_lshl_add_u32 v16, v3, 3, v16
    v_mul_u32_u24 v16, 192, v16
    v_and_b32 v17, 3, v0
    v_lshl_add_u32 v16, v17, 3, v16
    v_and_b32 v17, 16, v0
    v_lshl_add_u32 v16, v17, 1, v16
    s_lshl_b32 s86, s58, 6
    v_add_u32 v8, s86, v16
    v_xor_b32 v9, 32, v8
    s_lshl_b32 s86, s59, 6
    v_add_u32 v10, s86, v16
    v_xor_b32 v11, 32, v10
    s_lshl_b32 s86, s60, 6
    v_add_u32 v12, s86, v16
    v_xor_b32 v13, 32, v12
    v_add_u32 v22, 61440, v8
    v_add_u32 v23, 61440, v9
    v_and_b32 v17, 1, v0
    v_mul_u32_u24 v16, 1280, v17
    v_lshl_add_u32 v16, v3, 4, v16
    v_add_u32 v16, 161280, v16
    ds_read_b128 v[96:99], v16 offset:0
    ds_read_b64_tr_b16 v[100:101], v8 offset:0
    ds_read_b64_tr_b16 v[102:103], v8 offset:768
    ds_read_b64_tr_b16 v[104:105], v9 offset:0
    ds_read_b64_tr_b16 v[106:107], v9 offset:768
    ds_read_b128 v[108:111], v16 offset:64
    ds_read_b64_tr_b16 v[112:113], v8 offset:6144
    ds_read_b64_tr_b16 v[114:115], v8 offset:6912
    ds_read_b64_tr_b16 v[116:117], v9 offset:6144
    ds_read_b64_tr_b16 v[118:119], v9 offset:6912
    ds_read_b128 v[120:123], v16 offset:128
    ds_read_b64_tr_b16 v[124:125], v8 offset:12288
    ds_read_b64_tr_b16 v[126:127], v8 offset:13056
    ds_read_b64_tr_b16 v[128:129], v9 offset:12288
    ds_read_b64_tr_b16 v[130:131], v9 offset:13056
    v_mul_u32_u24 v17, 384, v17
    v_lshl_add_u32 v17, v3, 4, v17
    s_lshl_b32 s86, s58, 7
    s_add_u32 s86, s86, 143360
    v_add_u32 v17, s86, v17
    v_and_b32 v18, 7, v0
    v_lshlrev_b32 v18, 7, v18
    s_lshr_b32 s87, s3, 1
    s_lshl1_add_u32 s86, s4, s87
    s_lshl_b32 s86, s86, 10
    s_add_u32 s86, s86, 0xa000
    s_lshl2_add_u32 s91, s4, s3
    s_mul_i32 s61, s91, 40960
    s_add_u32 s61, s61, 0x5a8000
    s_add_u32 s62, s61, 8192
    s_add_u32 s63, s61, 16384
    s_add_u32 s64, s61, 24576
    s_add_u32 s65, s61, 32768
    s_lshl_b32 s90, s91, 11
    s_add_u32 s90, s90, 0x40000
    v_lshlrev_b32 v19, 3, v0
    s_waitcnt lgkmcnt(10)
    v_mfma_f32_16x16x32_bf16 a[0:3], v[100:103], v[96:99], 0
    v_mfma_f32_16x16x32_bf16 a[4:7], v[104:107], v[96:99], 0
    ds_read_b128 v[132:135], v16 offset:192
    ds_read_b64_tr_b16 v[136:137], v8 offset:18432
    ds_read_b64_tr_b16 v[138:139], v8 offset:19200
    ds_read_b64_tr_b16 v[140:141], v9 offset:18432
    ds_read_b64_tr_b16 v[142:143], v9 offset:19200
    s_waitcnt lgkmcnt(10)
    v_mfma_f32_16x16x32_bf16 a[0:3], v[112:115], v[108:111], a[0:3]
    v_mfma_f32_16x16x32_bf16 a[4:7], v[116:119], v[108:111], a[4:7]
    ds_read_b128 v[144:147], v16 offset:256
    ds_read_b64_tr_b16 v[148:149], v8 offset:24576
    ds_read_b64_tr_b16 v[150:151], v8 offset:25344
    ds_read_b64_tr_b16 v[152:153], v9 offset:24576
    ds_read_b64_tr_b16 v[154:155], v9 offset:25344
    s_waitcnt lgkmcnt(10)
    v_mfma_f32_16x16x32_bf16 a[0:3], v[124:127], v[120:123], a[0:3]
    v_mfma_f32_16x16x32_bf16 a[4:7], v[128:131], v[120:123], a[4:7]
    ds_read_b128 v[156:159], v16 offset:320
    ds_read_b64_tr_b16 v[160:161], v8 offset:30720
    ds_read_b64_tr_b16 v[162:163], v8 offset:31488
    ds_read_b64_tr_b16 v[164:165], v9 offset:30720
    ds_read_b64_tr_b16 v[166:167], v9 offset:31488
    s_waitcnt lgkmcnt(10)
    v_mfma_f32_16x16x32_bf16 a[0:3], v[136:139], v[132:135], a[0:3]
    v_mfma_f32_16x16x32_bf16 a[4:7], v[140:143], v[132:135], a[4:7]
    ds_read_b128 v[168:171], v16 offset:384
    ds_read_b64_tr_b16 v[172:173], v8 offset:36864
    ds_read_b64_tr_b16 v[174:175], v8 offset:37632
    ds_read_b64_tr_b16 v[176:177], v9 offset:36864
    ds_read_b64_tr_b16 v[178:179], v9 offset:37632
    s_waitcnt lgkmcnt(10)
    v_mfma_f32_16x16x32_bf16 a[0:3], v[148:151], v[144:147], a[0:3]
    v_mfma_f32_16x16x32_bf16 a[4:7], v[152:155], v[144:147], a[4:7]
    ds_read_b128 v[180:183], v16 offset:448
    ds_read_b64_tr_b16 v[184:185], v8 offset:43008
    ds_read_b64_tr_b16 v[186:187], v8 offset:43776
    ds_read_b64_tr_b16 v[188:189], v9 offset:43008
    ds_read_b64_tr_b16 v[190:191], v9 offset:43776
    s_waitcnt lgkmcnt(10)
    v_mfma_f32_16x16x32_bf16 a[0:3], v[160:163], v[156:159], a[0:3]
    v_mfma_f32_16x16x32_bf16 a[4:7], v[164:167], v[156:159], a[4:7]
    ds_read_b128 v[192:195], v16 offset:512
    ds_read_b64_tr_b16 v[196:197], v8 offset:49152
    ds_read_b64_tr_b16 v[198:199], v8 offset:49920
    ds_read_b64_tr_b16 v[200:201], v9 offset:49152
    ds_read_b64_tr_b16 v[202:203], v9 offset:49920
    s_waitcnt lgkmcnt(10)
    v_mfma_f32_16x16x32_bf16 a[0:3], v[172:175], v[168:171], a[0:3]
    v_mfma_f32_16x16x32_bf16 a[4:7], v[176:179], v[168:171], a[4:7]
    ds_read_b128 v[204:207], v16 offset:576
    ds_read_b64_tr_b16 v[208:209], v8 offset:55296
    ds_read_b64_tr_b16 v[210:211], v8 offset:56064
    ds_read_b64_tr_b16 v[212:213], v9 offset:55296
    ds_read_b64_tr_b16 v[214:215], v9 offset:56064
    s_waitcnt lgkmcnt(10)
    v_mfma_f32_16x16x32_bf16 a[0:3], v[184:187], v[180:183], a[0:3]
    v_mfma_f32_16x16x32_bf16 a[4:7], v[188:191], v[180:183], a[4:7]
    ds_read_b128 v[96:99], v16 offset:640
    ds_read_b64_tr_b16 v[100:101], v22 offset:0
    ds_read_b64_tr_b16 v[102:103], v22 offset:768
    ds_read_b64_tr_b16 v[104:105], v23 offset:0
    ds_read_b64_tr_b16 v[106:107], v23 offset:768
    s_waitcnt lgkmcnt(10)
    v_mfma_f32_16x16x32_bf16 a[0:3], v[196:199], v[192:195], a[0:3]
    v_mfma_f32_16x16x32_bf16 a[4:7], v[200:203], v[192:195], a[4:7]
    ds_read_b128 v[108:111], v16 offset:704
    ds_read_b64_tr_b16 v[112:113], v22 offset:6144
    ds_read_b64_tr_b16 v[114:115], v22 offset:6912
    ds_read_b64_tr_b16 v[116:117], v23 offset:6144
    ds_read_b64_tr_b16 v[118:119], v23 offset:6912
    s_waitcnt lgkmcnt(10)
    v_mfma_f32_16x16x32_bf16 a[0:3], v[208:211], v[204:207], a[0:3]
    v_mfma_f32_16x16x32_bf16 a[4:7], v[212:215], v[204:207], a[4:7]
    ds_read_b128 v[120:123], v16 offset:768
    ds_read_b64_tr_b16 v[124:125], v22 offset:12288
    ds_read_b64_tr_b16 v[126:127], v22 offset:13056
    ds_read_b64_tr_b16 v[128:129], v23 offset:12288
    ds_read_b64_tr_b16 v[130:131], v23 offset:13056
    s_waitcnt lgkmcnt(10)
    v_mfma_f32_16x16x32_bf16 a[0:3], v[100:103], v[96:99], a[0:3]
    v_mfma_f32_16x16x32_bf16 a[4:7], v[104:107], v[96:99], a[4:7]
    ds_read_b128 v[132:135], v16 offset:832
    ds_read_b64_tr_b16 v[136:137], v22 offset:18432
    ds_read_b64_tr_b16 v[138:139], v22 offset:19200
    ds_read_b64_tr_b16 v[140:141], v23 offset:18432
    ds_read_b64_tr_b16 v[142:143], v23 offset:19200
    s_waitcnt lgkmcnt(10)
    v_mfma_f32_16x16x32_bf16 a[0:3], v[112:115], v[108:111], a[0:3]
    v_mfma_f32_16x16x32_bf16 a[4:7], v[116:119], v[108:111], a[4:7]
    s_waitcnt lgkmcnt(5)
    v_mfma_f32_16x16x32_bf16 a[0:3], v[124:127], v[120:123], a[0:3]
    v_mfma_f32_16x16x32_bf16 a[4:7], v[128:131], v[120:123], a[4:7]
    s_waitcnt lgkmcnt(0)
    v_mfma_f32_16x16x32_bf16 a[0:3], v[136:139], v[132:135], a[0:3]
    v_mfma_f32_16x16x32_bf16 a[4:7], v[140:143], v[132:135], a[4:7]
    ds_read_b64_tr_b16 v[24:25], v8 offset:0
    ds_read_b64_tr_b16 v[26:27], v8 offset:768
    ds_read_b64_tr_b16 v[28:29], v9 offset:0
    ds_read_b64_tr_b16 v[30:31], v9 offset:768
    ds_read_b64_tr_b16 v[32:33], v10 offset:0
    ds_read_b64_tr_b16 v[34:35], v10 offset:768
    ds_read_b64_tr_b16 v[36:37], v11 offset:0
    ds_read_b64_tr_b16 v[38:39], v11 offset:768
    ds_read_b64_tr_b16 v[40:41], v12 offset:0
    ds_read_b64_tr_b16 v[42:43], v12 offset:768
    ds_read_b64_tr_b16 v[44:45], v13 offset:0
    ds_read_b64_tr_b16 v[46:47], v13 offset:768
    s_mov_b32 s94, 0x8000
poll_33:
    buffer_load_dword v20, v18, s[40:43], s86 offen sc1
    s_waitcnt vmcnt(0)
    v_cmp_ne_u32 vcc, s6, v20
    s_cbranch_vccz pdone_34
    s_sub_u32 s94, s94, 1
    s_cmp_lg_u32 s94, 0
    s_cbranch_scc1 poll_33
pdone_34:
    buffer_load_dwordx4 v[96:99], v1, s[40:43], s61 offen offset:0 sc1
    buffer_load_dwordx4 v[100:103], v5, s[40:43], s63 offen offset:0 sc1
    buffer_load_dwordx4 v[104:107], v1, s[40:43], s61 offen offset:1024 sc1
    buffer_load_dwordx4 v[108:111], v5, s[40:43], s63 offen offset:1024 sc1
    buffer_load_dwordx4 v[112:115], v1, s[40:43], s61 offen offset:2048 sc1
    buffer_load_dwordx4 v[116:119], v5, s[40:43], s63 offen offset:2048 sc1
    buffer_load_dwordx4 v[120:123], v1, s[40:43], s61 offen offset:3072 sc1
    buffer_load_dwordx4 v[124:127], v5, s[40:43], s63 offen offset:3072 sc1
    buffer_load_dwordx4 v[128:131], v5, s[40:43], s61 offen offset:0 sc1
    buffer_load_dwordx4 v[132:135], v1, s[40:43], s64 offen offset:0 sc1
    buffer_load_dwordx4 v[136:139], v5, s[40:43], s61 offen offset:1024 sc1
    buffer_load_dwordx4 v[140:143], v1, s[40:43], s64 offen offset:1024 sc1
    s_waitcnt vmcnt(10)
    s_waitcnt lgkmcnt(8)
    v_mfma_f32_16x16x32_bf16 v[48:51], v[24:27], v[96:99], 0
    v_mfma_f32_16x16x32_bf16 v[72:75], v[24:27], v[100:103], 0
    v_mfma_f32_16x16x32_bf16 v[52:55], v[28:31], v[96:99], 0
    ds_read_b64_tr_b16 v[24:25], v8 offset:6144
    buffer_load_dwordx4 v[144:147], v5, s[40:43], s61 offen offset:2048 sc1
    v_mfma_f32_16x16x32_bf16 v[76:79], v[28:31], v[100:103], 0
    ds_read_b64_tr_b16 v[26:27], v8 offset:6912
    s_waitcnt lgkmcnt(6)
    v_mfma_f32_16x16x32_bf16 v[56:59], v[32:35], v[96:99], 0
    ds_read_b64_tr_b16 v[28:29], v9 offset:6144
    v_mfma_f32_16x16x32_bf16 v[80:83], v[32:35], v[100:103], 0
    ds_read_b64_tr_b16 v[30:31], v9 offset:6912
    v_mfma_f32_16x16x32_bf16 v[60:63], v[36:39], v[96:99], 0
    ds_read_b64_tr_b16 v[32:33], v10 offset:6144
    buffer_load_dwordx4 v[148:151], v1, s[40:43], s64 offen offset:2048 sc1
    v_mfma_f32_16x16x32_bf16 v[84:87], v[36:39], v[100:103], 0
    ds_read_b64_tr_b16 v[34:35], v10 offset:6912
    s_waitcnt lgkmcnt(8)
    v_mfma_f32_16x16x32_bf16 v[64:67], v[40:43], v[96:99], 0
    ds_read_b64_tr_b16 v[36:37], v11 offset:6144
    v_mfma_f32_16x16x32_bf16 v[88:91], v[40:43], v[100:103], 0
    ds_read_b64_tr_b16 v[38:39], v11 offset:6912
    s_waitcnt lgkmcnt(8)
    v_mfma_f32_16x16x32_bf16 v[68:71], v[44:47], v[96:99], 0
    ds_read_b64_tr_b16 v[40:41], v12 offset:6144
    buffer_load_dwordx4 v[152:155], v5, s[40:43], s61 offen offset:3072 sc1
    v_mfma_f32_16x16x32_bf16 v[92:95], v[44:47], v[100:103], 0
    ds_read_b64_tr_b16 v[42:43], v12 offset:6912
    s_waitcnt vmcnt(11)
    s_waitcnt lgkmcnt(6)
    v_mfma_f32_16x16x32_bf16 v[48:51], v[24:27], v[104:107], v[48:51]
    ds_read_b64_tr_b16 v[44:45], v13 offset:6144
    v_mfma_f32_16x16x32_bf16 v[72:75], v[24:27], v[108:111], v[72:75]
    ds_read_b64_tr_b16 v[46:47], v13 offset:6912
    v_mfma_f32_16x16x32_bf16 v[52:55], v[28:31], v[104:107], v[52:55]
    ds_read_b64_tr_b16 v[24:25], v8 offset:12288
    buffer_load_dwordx4 v[156:159], v1, s[40:43], s64 offen offset:3072 sc1
    v_mfma_f32_16x16x32_bf16 v[76:79], v[28:31], v[108:111], v[76:79]
    ds_read_b64_tr_b16 v[26:27], v8 offset:13056
    s_waitcnt lgkmcnt(6)
    v_mfma_f32_16x16x32_bf16 v[56:59], v[32:35], v[104:107], v[56:59]
    ds_read_b64_tr_b16 v[28:29], v9 offset:12288
    v_mfma_f32_16x16x32_bf16 v[80:83], v[32:35], v[108:111], v[80:83]
    ds_read_b64_tr_b16 v[30:31], v9 offset:13056
    v_mfma_f32_16x16x32_bf16 v[60:63], v[36:39], v[104:107], v[60:63]
    ds_read_b64_tr_b16 v[32:33], v10 offset:12288
    buffer_load_dwordx4 v[160:163], v1, s[40:43], s62 offen offset:0 sc1
    v_mfma_f32_16x16x32_bf16 v[84:87], v[36:39], v[108:111], v[84:87]
    ds_read_b64_tr_b16 v[34:35], v10 offset:13056
    s_waitcnt lgkmcnt(8)
    v_mfma_f32_16x16x32_bf16 v[64:67], v[40:43], v[104:107], v[64:67]
    ds_read_b64_tr_b16 v[36:37], v11 offset:12288
    v_mfma_f32_16x16x32_bf16 v[88:91], v[40:43], v[108:111], v[88:91]
    ds_read_b64_tr_b16 v[38:39], v11 offset:13056
    s_waitcnt lgkmcnt(8)
    v_mfma_f32_16x16x32_bf16 v[68:71], v[44:47], v[104:107], v[68:71]
    ds_read_b64_tr_b16 v[40:41], v12 offset:12288
    buffer_load_dwordx4 v[164:167], v5, s[40:43], s64 offen offset:0 sc1
    v_mfma_f32_16x16x32_bf16 v[92:95], v[44:47], v[108:111], v[92:95]
    ds_read_b64_tr_b16 v[42:43], v12 offset:13056
    s_waitcnt vmcnt(12)
    s_waitcnt lgkmcnt(6)
    v_mfma_f32_16x16x32_bf16 v[48:51], v[24:27], v[112:115], v[48:51]
    ds_read_b64_tr_b16 v[44:45], v13 offset:12288
    v_mfma_f32_16x16x32_bf16 v[72:75], v[24:27], v[116:119], v[72:75]
    ds_read_b64_tr_b16 v[46:47], v13 offset:13056
    v_mfma_f32_16x16x32_bf16 v[52:55], v[28:31], v[112:115], v[52:55]
    ds_read_b64_tr_b16 v[24:25], v8 offset:18432
    buffer_load_dwordx4 v[168:171], v1, s[40:43], s62 offen offset:1024 sc1
    v_mfma_f32_16x16x32_bf16 v[76:79], v[28:31], v[116:119], v[76:79]
    ds_read_b64_tr_b16 v[26:27], v8 offset:19200
    s_waitcnt lgkmcnt(6)
    v_mfma_f32_16x16x32_bf16 v[56:59], v[32:35], v[112:115], v[56:59]
    ds_read_b64_tr_b16 v[28:29], v9 offset:18432
    v_mfma_f32_16x16x32_bf16 v[80:83], v[32:35], v[116:119], v[80:83]
    ds_read_b64_tr_b16 v[30:31], v9 offset:19200
    v_mfma_f32_16x16x32_bf16 v[60:63], v[36:39], v[112:115], v[60:63]
    ds_read_b64_tr_b16 v[32:33], v10 offset:18432
    buffer_load_dwordx4 v[172:175], v5, s[40:43], s64 offen offset:1024 sc1
    v_mfma_f32_16x16x32_bf16 v[84:87], v[36:39], v[116:119], v[84:87]
    ds_read_b64_tr_b16 v[34:35], v10 offset:19200
    s_waitcnt lgkmcnt(8)
    v_mfma_f32_16x16x32_bf16 v[64:67], v[40:43], v[112:115], v[64:67]
    ds_read_b64_tr_b16 v[36:37], v11 offset:18432
    v_mfma_f32_16x16x32_bf16 v[88:91], v[40:43], v[116:119], v[88:91]
    ds_read_b64_tr_b16 v[38:39], v11 offset:19200
    s_waitcnt lgkmcnt(8)
    v_mfma_f32_16x16x32_bf16 v[68:71], v[44:47], v[112:115], v[68:71]
    ds_read_b64_tr_b16 v[40:41], v12 offset:18432
    buffer_load_dwordx4 v[176:179], v5, s[40:43], s62 offen offset:2048 sc1
    v_mfma_f32_16x16x32_bf16 v[92:95], v[44:47], v[116:119], v[92:95]
    ds_read_b64_tr_b16 v[42:43], v12 offset:19200
    s_waitcnt vmcnt(13)
    s_waitcnt lgkmcnt(6)
    v_mfma_f32_16x16x32_bf16 v[48:51], v[24:27], v[120:123], v[48:51]
    ds_read_b64_tr_b16 v[44:45], v13 offset:18432
    v_mfma_f32_16x16x32_bf16 v[72:75], v[24:27], v[124:127], v[72:75]
    ds_read_b64_tr_b16 v[46:47], v13 offset:19200
    v_mfma_f32_16x16x32_bf16 v[52:55], v[28:31], v[120:123], v[52:55]
    ds_read_b64_tr_b16 v[24:25], v8 offset:24576
    buffer_load_dwordx4 v[180:183], v1, s[40:43], s65 offen offset:2048 sc1
    v_mfma_f32_16x16x32_bf16 v[76:79], v[28:31], v[124:127], v[76:79]
    ds_read_b64_tr_b16 v[26:27], v8 offset:25344
    s_waitcnt lgkmcnt(6)
    v_mfma_f32_16x16x32_bf16 v[56:59], v[32:35], v[120:123], v[56:59]
    ds_read_b64_tr_b16 v[28:29], v9 offset:24576
    v_mfma_f32_16x16x32_bf16 v[80:83], v[32:35], v[124:127], v[80:83]
    ds_read_b64_tr_b16 v[30:31], v9 offset:25344
    v_mfma_f32_16x16x32_bf16 v[60:63], v[36:39], v[120:123], v[60:63]
    ds_read_b64_tr_b16 v[32:33], v10 offset:24576
    buffer_load_dwordx4 v[184:187], v5, s[40:43], s62 offen offset:3072 sc1
    v_mfma_f32_16x16x32_bf16 v[84:87], v[36:39], v[124:127], v[84:87]
    ds_read_b64_tr_b16 v[34:35], v10 offset:25344
    s_waitcnt lgkmcnt(8)
    v_mfma_f32_16x16x32_bf16 v[64:67], v[40:43], v[120:123], v[64:67]
    ds_read_b64_tr_b16 v[36:37], v11 offset:24576
    v_mfma_f32_16x16x32_bf16 v[88:91], v[40:43], v[124:127], v[88:91]
    ds_read_b64_tr_b16 v[38:39], v11 offset:25344
    s_waitcnt lgkmcnt(8)
    v_mfma_f32_16x16x32_bf16 v[68:71], v[44:47], v[120:123], v[68:71]
    ds_read_b64_tr_b16 v[40:41], v12 offset:24576
    buffer_load_dwordx4 v[188:191], v1, s[40:43], s65 offen offset:3072 sc1
    v_mfma_f32_16x16x32_bf16 v[92:95], v[44:47], v[124:127], v[92:95]
    ds_read_b64_tr_b16 v[42:43], v12 offset:25344
    s_waitcnt vmcnt(14)
    s_waitcnt lgkmcnt(6)
    v_mfma_f32_16x16x32_bf16 v[48:51], v[24:27], v[128:131], v[48:51]
    ds_read_b64_tr_b16 v[44:45], v13 offset:24576
    v_mfma_f32_16x16x32_bf16 v[72:75], v[24:27], v[132:135], v[72:75]
    ds_read_b64_tr_b16 v[46:47], v13 offset:25344
    v_mfma_f32_16x16x32_bf16 v[52:55], v[28:31], v[128:131], v[52:55]
    ds_read_b64_tr_b16 v[24:25], v8 offset:30720
    buffer_load_dwordx4 v[192:195], v1, s[40:43], s63 offen offset:0 sc1
    v_mfma_f32_16x16x32_bf16 v[76:79], v[28:31], v[132:135], v[76:79]
    ds_read_b64_tr_b16 v[26:27], v8 offset:31488
    s_waitcnt lgkmcnt(6)
    v_mfma_f32_16x16x32_bf16 v[56:59], v[32:35], v[128:131], v[56:59]
    ds_read_b64_tr_b16 v[28:29], v9 offset:30720
    v_mfma_f32_16x16x32_bf16 v[80:83], v[32:35], v[132:135], v[80:83]
    ds_read_b64_tr_b16 v[30:31], v9 offset:31488
    v_mfma_f32_16x16x32_bf16 v[60:63], v[36:39], v[128:131], v[60:63]
    ds_read_b64_tr_b16 v[32:33], v10 offset:30720
    buffer_load_dwordx4 v[196:199], v5, s[40:43], s65 offen offset:0 sc1
    v_mfma_f32_16x16x32_bf16 v[84:87], v[36:39], v[132:135], v[84:87]
    ds_read_b64_tr_b16 v[34:35], v10 offset:31488
    s_waitcnt lgkmcnt(8)
    v_mfma_f32_16x16x32_bf16 v[64:67], v[40:43], v[128:131], v[64:67]
    ds_read_b64_tr_b16 v[36:37], v11 offset:30720
    v_mfma_f32_16x16x32_bf16 v[88:91], v[40:43], v[132:135], v[88:91]
    ds_read_b64_tr_b16 v[38:39], v11 offset:31488
    s_waitcnt lgkmcnt(8)
    v_mfma_f32_16x16x32_bf16 v[68:71], v[44:47], v[128:131], v[68:71]
    ds_read_b64_tr_b16 v[40:41], v12 offset:30720
    buffer_load_dwordx4 v[200:203], v1, s[40:43], s63 offen offset:1024 sc1
    v_mfma_f32_16x16x32_bf16 v[92:95], v[44:47], v[132:135], v[92:95]
    ds_read_b64_tr_b16 v[42:43], v12 offset:31488
    s_waitcnt vmcnt(15)
    s_waitcnt lgkmcnt(6)
    v_mfma_f32_16x16x32_bf16 v[48:51], v[24:27], v[136:139], v[48:51]
    ds_read_b64_tr_b16 v[44:45], v13 offset:30720
    v_mfma_f32_16x16x32_bf16 v[72:75], v[24:27], v[140:143], v[72:75]
    ds_read_b64_tr_b16 v[46:47], v13 offset:31488
    v_mfma_f32_16x16x32_bf16 v[52:55], v[28:31], v[136:139], v[52:55]
    ds_read_b64_tr_b16 v[24:25], v8 offset:36864
    buffer_load_dwordx4 v[204:207], v5, s[40:43], s65 offen offset:1024 sc1
    v_mfma_f32_16x16x32_bf16 v[76:79], v[28:31], v[140:143], v[76:79]
    ds_read_b64_tr_b16 v[26:27], v8 offset:37632
    s_waitcnt lgkmcnt(6)
    v_mfma_f32_16x16x32_bf16 v[56:59], v[32:35], v[136:139], v[56:59]
    ds_read_b64_tr_b16 v[28:29], v9 offset:36864
    v_mfma_f32_16x16x32_bf16 v[80:83], v[32:35], v[140:143], v[80:83]
    ds_read_b64_tr_b16 v[30:31], v9 offset:37632
    v_mfma_f32_16x16x32_bf16 v[60:63], v[36:39], v[136:139], v[60:63]
    ds_read_b64_tr_b16 v[32:33], v10 offset:36864
    buffer_load_dwordx4 v[208:211], v1, s[40:43], s63 offen offset:2048 sc1
    v_mfma_f32_16x16x32_bf16 v[84:87], v[36:39], v[140:143], v[84:87]
    ds_read_b64_tr_b16 v[34:35], v10 offset:37632
    s_waitcnt lgkmcnt(8)
    v_mfma_f32_16x16x32_bf16 v[64:67], v[40:43], v[136:139], v[64:67]
    ds_read_b64_tr_b16 v[36:37], v11 offset:36864
    v_mfma_f32_16x16x32_bf16 v[88:91], v[40:43], v[140:143], v[88:91]
    ds_read_b64_tr_b16 v[38:39], v11 offset:37632
    s_waitcnt lgkmcnt(8)
    v_mfma_f32_16x16x32_bf16 v[68:71], v[44:47], v[136:139], v[68:71]
    ds_read_b64_tr_b16 v[40:41], v12 offset:36864
    buffer_load_dwordx4 v[212:215], v5, s[40:43], s65 offen offset:2048 sc1
    v_mfma_f32_16x16x32_bf16 v[92:95], v[44:47], v[140:143], v[92:95]
    ds_read_b64_tr_b16 v[42:43], v12 offset:37632
    s_waitcnt vmcnt(16)
    s_waitcnt lgkmcnt(6)
    v_mfma_f32_16x16x32_bf16 v[48:51], v[24:27], v[144:147], v[48:51]
    ds_read_b64_tr_b16 v[44:45], v13 offset:36864
    v_mfma_f32_16x16x32_bf16 v[72:75], v[24:27], v[148:151], v[72:75]
    ds_read_b64_tr_b16 v[46:47], v13 offset:37632
    v_mfma_f32_16x16x32_bf16 v[52:55], v[28:31], v[144:147], v[52:55]
    ds_read_b64_tr_b16 v[24:25], v8 offset:43008
    buffer_load_dwordx4 v[216:219], v1, s[40:43], s63 offen offset:3072 sc1
    v_mfma_f32_16x16x32_bf16 v[76:79], v[28:31], v[148:151], v[76:79]
    ds_read_b64_tr_b16 v[26:27], v8 offset:43776
    s_waitcnt lgkmcnt(6)
    v_mfma_f32_16x16x32_bf16 v[56:59], v[32:35], v[144:147], v[56:59]
    ds_read_b64_tr_b16 v[28:29], v9 offset:43008
    v_mfma_f32_16x16x32_bf16 v[80:83], v[32:35], v[148:151], v[80:83]
    ds_read_b64_tr_b16 v[30:31], v9 offset:43776
    v_mfma_f32_16x16x32_bf16 v[60:63], v[36:39], v[144:147], v[60:63]
    ds_read_b64_tr_b16 v[32:33], v10 offset:43008
    buffer_load_dwordx4 v[220:223], v5, s[40:43], s65 offen offset:3072 sc1
    v_mfma_f32_16x16x32_bf16 v[84:87], v[36:39], v[148:151], v[84:87]
    ds_read_b64_tr_b16 v[34:35], v10 offset:43776
    s_waitcnt lgkmcnt(8)
    v_mfma_f32_16x16x32_bf16 v[64:67], v[40:43], v[144:147], v[64:67]
    ds_read_b64_tr_b16 v[36:37], v11 offset:43008
    v_mfma_f32_16x16x32_bf16 v[88:91], v[40:43], v[148:151], v[88:91]
    ds_read_b64_tr_b16 v[38:39], v11 offset:43776
    s_waitcnt lgkmcnt(8)
    v_mfma_f32_16x16x32_bf16 v[68:71], v[44:47], v[144:147], v[68:71]
    ds_read_b64_tr_b16 v[40:41], v12 offset:43008
    buffer_load_dwordx4 v[224:227], v1, s[40:43], s62 offen offset:2048 sc1
    v_mfma_f32_16x16x32_bf16 v[92:95], v[44:47], v[148:151], v[92:95]
    ds_read_b64_tr_b16 v[42:43], v12 offset:43776
    s_waitcnt vmcnt(17)
    s_waitcnt lgkmcnt(6)
    v_mfma_f32_16x16x32_bf16 v[48:51], v[24:27], v[152:155], v[48:51]
    ds_read_b64_tr_b16 v[44:45], v13 offset:43008
    v_mfma_f32_16x16x32_bf16 v[72:75], v[24:27], v[156:159], v[72:75]
    ds_read_b64_tr_b16 v[46:47], v13 offset:43776
    v_mfma_f32_16x16x32_bf16 v[52:55], v[28:31], v[152:155], v[52:55]
    ds_read_b64_tr_b16 v[24:25], v8 offset:49152
    buffer_load_dwordx4 v[228:231], v5, s[40:43], s64 offen offset:2048 sc1
    v_mfma_f32_16x16x32_bf16 v[76:79], v[28:31], v[156:159], v[76:79]
    ds_read_b64_tr_b16 v[26:27], v8 offset:49920
    s_waitcnt lgkmcnt(6)
    v_mfma_f32_16x16x32_bf16 v[56:59], v[32:35], v[152:155], v[56:59]
    ds_read_b64_tr_b16 v[28:29], v9 offset:49152
    v_mfma_f32_16x16x32_bf16 v[80:83], v[32:35], v[156:159], v[80:83]
    ds_read_b64_tr_b16 v[30:31], v9 offset:49920
    v_mfma_f32_16x16x32_bf16 v[60:63], v[36:39], v[152:155], v[60:63]
    ds_read_b64_tr_b16 v[32:33], v10 offset:49152
    buffer_load_dwordx4 v[232:235], v1, s[40:43], s62 offen offset:3072 sc1
    v_mfma_f32_16x16x32_bf16 v[84:87], v[36:39], v[156:159], v[84:87]
    ds_read_b64_tr_b16 v[34:35], v10 offset:49920
    s_waitcnt lgkmcnt(8)
    v_mfma_f32_16x16x32_bf16 v[64:67], v[40:43], v[152:155], v[64:67]
    ds_read_b64_tr_b16 v[36:37], v11 offset:49152
    v_mfma_f32_16x16x32_bf16 v[88:91], v[40:43], v[156:159], v[88:91]
    ds_read_b64_tr_b16 v[38:39], v11 offset:49920
    s_waitcnt lgkmcnt(8)
    v_mfma_f32_16x16x32_bf16 v[68:71], v[44:47], v[152:155], v[68:71]
    ds_read_b64_tr_b16 v[40:41], v12 offset:49152
    buffer_load_dwordx4 v[236:239], v5, s[40:43], s64 offen offset:3072 sc1
    v_mfma_f32_16x16x32_bf16 v[92:95], v[44:47], v[156:159], v[92:95]
    ds_read_b64_tr_b16 v[42:43], v12 offset:49920
    s_waitcnt vmcnt(18)
    s_waitcnt lgkmcnt(6)
    v_mfma_f32_16x16x32_bf16 v[48:51], v[24:27], v[160:163], v[48:51]
    ds_read_b64_tr_b16 v[44:45], v13 offset:49152
    v_mfma_f32_16x16x32_bf16 v[72:75], v[24:27], v[164:167], v[72:75]
    ds_read_b64_tr_b16 v[46:47], v13 offset:49920
    v_mfma_f32_16x16x32_bf16 v[52:55], v[28:31], v[160:163], v[52:55]
    ds_read_b64_tr_b16 v[24:25], v8 offset:55296
    buffer_load_dwordx4 v[240:243], v5, s[40:43], s62 offen offset:0 sc1
    v_mfma_f32_16x16x32_bf16 v[76:79], v[28:31], v[164:167], v[76:79]
    ds_read_b64_tr_b16 v[26:27], v8 offset:56064
    s_waitcnt lgkmcnt(6)
    v_mfma_f32_16x16x32_bf16 v[56:59], v[32:35], v[160:163], v[56:59]
    ds_read_b64_tr_b16 v[28:29], v9 offset:55296
    v_mfma_f32_16x16x32_bf16 v[80:83], v[32:35], v[164:167], v[80:83]
    ds_read_b64_tr_b16 v[30:31], v9 offset:56064
    v_mfma_f32_16x16x32_bf16 v[60:63], v[36:39], v[160:163], v[60:63]
    ds_read_b64_tr_b16 v[32:33], v10 offset:55296
    buffer_load_dwordx4 v[244:247], v1, s[40:43], s65 offen offset:0 sc1
    v_mfma_f32_16x16x32_bf16 v[84:87], v[36:39], v[164:167], v[84:87]
    ds_read_b64_tr_b16 v[34:35], v10 offset:56064
    s_waitcnt lgkmcnt(8)
    v_mfma_f32_16x16x32_bf16 v[64:67], v[40:43], v[160:163], v[64:67]
    ds_read_b64_tr_b16 v[36:37], v11 offset:55296
    v_mfma_f32_16x16x32_bf16 v[88:91], v[40:43], v[164:167], v[88:91]
    ds_read_b64_tr_b16 v[38:39], v11 offset:56064
    s_waitcnt lgkmcnt(8)
    v_mfma_f32_16x16x32_bf16 v[68:71], v[44:47], v[160:163], v[68:71]
    ds_read_b64_tr_b16 v[40:41], v12 offset:55296
    buffer_load_dwordx4 v[248:251], v5, s[40:43], s62 offen offset:1024 sc1
    v_mfma_f32_16x16x32_bf16 v[92:95], v[44:47], v[164:167], v[92:95]
    ds_read_b64_tr_b16 v[42:43], v12 offset:56064
    s_barrier
    s_waitcnt vmcnt(19)
    s_waitcnt lgkmcnt(6)
    v_mfma_f32_16x16x32_bf16 v[48:51], v[24:27], v[168:171], v[48:51]
    ds_read_b64_tr_b16 v[44:45], v13 offset:55296
    ds_read_b128 a[12:15], v16 offset:896
    v_mfma_f32_16x16x32_bf16 v[72:75], v[24:27], v[172:175], v[72:75]
    ds_read_b64_tr_b16 v[46:47], v13 offset:56064
    v_mfma_f32_16x16x32_bf16 v[52:55], v[28:31], v[168:171], v[52:55]
    v_add_u32 v8, 61440, v8
    ds_read_b64_tr_b16 v[24:25], v8 offset:24576
    buffer_load_dwordx4 v[252:255], v1, s[40:43], s65 offen offset:1024 sc1
    v_mfma_f32_16x16x32_bf16 v[76:79], v[28:31], v[172:175], v[76:79]
    ds_read_b64_tr_b16 v[26:27], v8 offset:25344
    s_waitcnt lgkmcnt(7)
    v_mfma_f32_16x16x32_bf16 v[56:59], v[32:35], v[168:171], v[56:59]
    v_add_u32 v9, 61440, v9
    ds_read_b64_tr_b16 v[28:29], v9 offset:24576
    v_mfma_f32_16x16x32_bf16 v[80:83], v[32:35], v[172:175], v[80:83]
    ds_read_b64_tr_b16 v[30:31], v9 offset:25344
    v_mfma_f32_16x16x32_bf16 v[60:63], v[36:39], v[168:171], v[60:63]
    v_add_u32 v10, 61440, v10
    ds_read_b64_tr_b16 v[32:33], v10 offset:24576
    buffer_load_dwordx4 a[16:19], v1, s[40:43], s69 offen offset:0 sc1
    v_mfma_f32_16x16x32_bf16 v[84:87], v[36:39], v[172:175], v[84:87]
    ds_read_b64_tr_b16 v[34:35], v10 offset:25344
    s_waitcnt lgkmcnt(9)
    v_mfma_f32_16x16x32_bf16 v[64:67], v[40:43], v[168:171], v[64:67]
    v_add_u32 v11, 61440, v11
    ds_read_b64_tr_b16 v[36:37], v11 offset:24576
    v_mfma_f32_16x16x32_bf16 v[88:91], v[40:43], v[172:175], v[88:91]
    ds_read_b64_tr_b16 v[38:39], v11 offset:25344
    s_waitcnt lgkmcnt(8)
    v_mfma_f32_16x16x32_bf16 v[68:71], v[44:47], v[168:171], v[68:71]
    v_add_u32 v12, 61440, v12
    ds_read_b64_tr_b16 v[40:41], v12 offset:24576
    buffer_load_dwordx4 a[20:23], v1, s[40:43], s69 offen offset:1024 sc1
    v_mfma_f32_16x16x32_bf16 v[92:95], v[44:47], v[172:175], v[92:95]
    ds_read_b64_tr_b16 v[42:43], v12 offset:25344
    s_waitcnt vmcnt(20)
    s_waitcnt lgkmcnt(6)
    v_mfma_f32_16x16x32_bf16 v[48:51], v[24:27], v[176:179], v[48:51]
    v_add_u32 v13, 61440, v13
    ds_read_b64_tr_b16 v[44:45], v13 offset:24576
    ds_read_b128 a[8:11], v16 offset:960
    v_mfma_f32_16x16x32_bf16 v[72:75], v[24:27], v[180:183], v[72:75]
    ds_read_b64_tr_b16 v[46:47], v13 offset:25344
    v_mfma_f32_16x16x32_bf16 a[0:3], v[24:27], a[12:15], a[0:3]
    v_mfma_f32_16x16x32_bf16 v[52:55], v[28:31], v[176:179], v[52:55]
    ds_read_b64_tr_b16 v[24:25], v8 offset:30720
    buffer_load_dwordx4 a[24:27], v1, s[40:43], s69 offen offset:2048 sc1
    v_mfma_f32_16x16x32_bf16 v[76:79], v[28:31], v[180:183], v[76:79]
    ds_read_b64_tr_b16 v[26:27], v8 offset:31488
    v_mfma_f32_16x16x32_bf16 a[4:7], v[28:31], a[12:15], a[4:7]
    s_waitcnt lgkmcnt(7)
    v_mfma_f32_16x16x32_bf16 v[56:59], v[32:35], v[176:179], v[56:59]
    ds_read_b64_tr_b16 v[28:29], v9 offset:30720
    v_mfma_f32_16x16x32_bf16 v[80:83], v[32:35], v[180:183], v[80:83]
    ds_read_b64_tr_b16 v[30:31], v9 offset:31488
    v_mfma_f32_16x16x32_bf16 v[60:63], v[36:39], v[176:179], v[60:63]
    ds_read_b64_tr_b16 v[32:33], v10 offset:30720
    buffer_load_dwordx4 a[28:31], v1, s[40:43], s69 offen offset:3072 sc1
    v_mfma_f32_16x16x32_bf16 v[84:87], v[36:39], v[180:183], v[84:87]
    ds_read_b64_tr_b16 v[34:35], v10 offset:31488
    s_waitcnt lgkmcnt(9)
    v_mfma_f32_16x16x32_bf16 v[64:67], v[40:43], v[176:179], v[64:67]
    ds_read_b64_tr_b16 v[36:37], v11 offset:30720
    v_mfma_f32_16x16x32_bf16 v[88:91], v[40:43], v[180:183], v[88:91]
    ds_read_b64_tr_b16 v[38:39], v11 offset:31488
    s_waitcnt lgkmcnt(8)
    v_mfma_f32_16x16x32_bf16 v[68:71], v[44:47], v[176:179], v[68:71]
    ds_read_b64_tr_b16 v[40:41], v12 offset:30720
    buffer_load_dwordx4 a[32:35], v5, s[40:43], s69 offen offset:0 sc1
    s_add_u32 s69, s69, 40960
    v_mfma_f32_16x16x32_bf16 v[92:95], v[44:47], v[180:183], v[92:95]
    ds_read_b64_tr_b16 v[42:43], v12 offset:31488
    s_waitcnt vmcnt(21)
    s_waitcnt lgkmcnt(6)
    v_mfma_f32_16x16x32_bf16 v[48:51], v[24:27], v[184:187], v[48:51]
    ds_read_b64_tr_b16 v[44:45], v13 offset:30720
    ds_read_b128 a[12:15], v16 offset:1024
    v_mfma_f32_16x16x32_bf16 v[72:75], v[24:27], v[188:191], v[72:75]
    ds_read_b64_tr_b16 v[46:47], v13 offset:31488
    v_mfma_f32_16x16x32_bf16 a[0:3], v[24:27], a[8:11], a[0:3]
    v_mfma_f32_16x16x32_bf16 v[52:55], v[28:31], v[184:187], v[52:55]
    ds_read_b64_tr_b16 v[24:25], v8 offset:36864
    buffer_load_dwordx4 a[36:39], v1, s[40:43], s69 offen offset:0 sc1
    v_mfma_f32_16x16x32_bf16 v[76:79], v[28:31], v[188:191], v[76:79]
    ds_read_b64_tr_b16 v[26:27], v8 offset:37632
    v_mfma_f32_16x16x32_bf16 a[4:7], v[28:31], a[8:11], a[4:7]
    s_waitcnt lgkmcnt(7)
    v_mfma_f32_16x16x32_bf16 v[56:59], v[32:35], v[184:187], v[56:59]
    ds_read_b64_tr_b16 v[28:29], v9 offset:36864
    v_mfma_f32_16x16x32_bf16 v[80:83], v[32:35], v[188:191], v[80:83]
    ds_read_b64_tr_b16 v[30:31], v9 offset:37632
    v_mfma_f32_16x16x32_bf16 v[60:63], v[36:39], v[184:187], v[60:63]
    ds_read_b64_tr_b16 v[32:33], v10 offset:36864
    buffer_load_dwordx4 a[40:43], v1, s[40:43], s69 offen offset:1024 sc1
    v_mfma_f32_16x16x32_bf16 v[84:87], v[36:39], v[188:191], v[84:87]
    ds_read_b64_tr_b16 v[34:35], v10 offset:37632
    s_waitcnt lgkmcnt(9)
    v_mfma_f32_16x16x32_bf16 v[64:67], v[40:43], v[184:187], v[64:67]
    ds_read_b64_tr_b16 v[36:37], v11 offset:36864
    v_mfma_f32_16x16x32_bf16 v[88:91], v[40:43], v[188:191], v[88:91]
    ds_read_b64_tr_b16 v[38:39], v11 offset:37632
    s_waitcnt lgkmcnt(8)
    v_mfma_f32_16x16x32_bf16 v[68:71], v[44:47], v[184:187], v[68:71]
    ds_read_b64_tr_b16 v[40:41], v12 offset:36864
    buffer_load_dwordx4 a[44:47], v1, s[40:43], s69 offen offset:2048 sc1
    v_mfma_f32_16x16x32_bf16 v[92:95], v[44:47], v[188:191], v[92:95]
    ds_read_b64_tr_b16 v[42:43], v12 offset:37632
    s_waitcnt vmcnt(22)
    s_waitcnt lgkmcnt(6)
    v_mfma_f32_16x16x32_bf16 v[48:51], v[24:27], v[192:195], v[48:51]
    ds_read_b64_tr_b16 v[44:45], v13 offset:36864
    ds_read_b128 a[8:11], v16 offset:1088
    v_mfma_f32_16x16x32_bf16 v[72:75], v[24:27], v[196:199], v[72:75]
    ds_read_b64_tr_b16 v[46:47], v13 offset:37632
    buffer_load_dwordx2 v[184:185], v19, s[40:43], s90 offen offset:0 sc1
    v_mfma_f32_16x16x32_bf16 a[0:3], v[24:27], a[12:15], a[0:3]
    v_mfma_f32_16x16x32_bf16 v[52:55], v[28:31], v[192:195], v[52:55]
    ds_read_b64_tr_b16 v[24:25], v8 offset:43008
    v_mfma_f32_16x16x32_bf16 v[76:79], v[28:31], v[196:199], v[76:79]
    ds_read_b64_tr_b16 v[26:27], v8 offset:43776
    v_mfma_f32_16x16x32_bf16 a[4:7], v[28:31], a[12:15], a[4:7]
    s_waitcnt lgkmcnt(7)
    v_mfma_f32_16x16x32_bf16 v[56:59], v[32:35], v[192:195], v[56:59]
    ds_read_b64_tr_b16 v[28:29], v9 offset:43008
    buffer_load_dwordx2 v[186:187], v19, s[40:43], s90 offen offset:512 sc1
    v_mfma_f32_16x16x32_bf16 v[80:83], v[32:35], v[196:199], v[80:83]
    ds_read_b64_tr_b16 v[30:31], v9 offset:43776
    v_mfma_f32_16x16x32_bf16 v[60:63], v[36:39], v[192:195], v[60:63]
    ds_read_b64_tr_b16 v[32:33], v10 offset:43008
    v_mfma_f32_16x16x32_bf16 v[84:87], v[36:39], v[196:199], v[84:87]
    ds_read_b64_tr_b16 v[34:35], v10 offset:43776
    buffer_load_dwordx2 v[188:189], v19, s[40:43], s90 offen offset:1024 sc1
    s_waitcnt lgkmcnt(9)
    v_mfma_f32_16x16x32_bf16 v[64:67], v[40:43], v[192:195], v[64:67]
    ds_read_b64_tr_b16 v[36:37], v11 offset:43008
    v_mfma_f32_16x16x32_bf16 v[88:91], v[40:43], v[196:199], v[88:91]
    ds_read_b64_tr_b16 v[38:39], v11 offset:43776
    s_waitcnt lgkmcnt(8)
    v_mfma_f32_16x16x32_bf16 v[68:71], v[44:47], v[192:195], v[68:71]
    ds_read_b64_tr_b16 v[40:41], v12 offset:43008
    buffer_load_dwordx2 v[190:191], v19, s[40:43], s90 offen offset:1536 sc1
    v_mfma_f32_16x16x32_bf16 v[92:95], v[44:47], v[196:199], v[92:95]
    ds_read_b64_tr_b16 v[42:43], v12 offset:43776
    s_waitcnt vmcnt(24)
    s_waitcnt lgkmcnt(6)
    v_mfma_f32_16x16x32_bf16 v[48:51], v[24:27], v[200:203], v[48:51]
    ds_read_b64_tr_b16 v[44:45], v13 offset:43008
    ds_read_b128 a[12:15], v16 offset:1152
    v_mfma_f32_16x16x32_bf16 v[72:75], v[24:27], v[204:207], v[72:75]
    ds_read_b64_tr_b16 v[46:47], v13 offset:43776
    v_mfma_f32_16x16x32_bf16 a[0:3], v[24:27], a[8:11], a[0:3]
    v_mfma_f32_16x16x32_bf16 v[52:55], v[28:31], v[200:203], v[52:55]
    ds_read_b64_tr_b16 v[24:25], v8 offset:49152
    buffer_load_dwordx4 a[48:51], v1, s[40:43], s69 offen offset:3072 sc1
    v_mfma_f32_16x16x32_bf16 v[76:79], v[28:31], v[204:207], v[76:79]
    ds_read_b64_tr_b16 v[26:27], v8 offset:49920
    v_mfma_f32_16x16x32_bf16 a[4:7], v[28:31], a[8:11], a[4:7]
    s_waitcnt lgkmcnt(7)
    v_mfma_f32_16x16x32_bf16 v[56:59], v[32:35], v[200:203], v[56:59]
    ds_read_b64_tr_b16 v[28:29], v9 offset:49152
    v_mfma_f32_16x16x32_bf16 v[80:83], v[32:35], v[204:207], v[80:83]
    ds_read_b64_tr_b16 v[30:31], v9 offset:49920
    v_mfma_f32_16x16x32_bf16 v[60:63], v[36:39], v[200:203], v[60:63]
    ds_read_b64_tr_b16 v[32:33], v10 offset:49152
    buffer_load_dwordx4 a[52:55], v5, s[40:43], s69 offen offset:0 sc1
    s_add_u32 s69, s69, 40960
    v_mfma_f32_16x16x32_bf16 v[84:87], v[36:39], v[204:207], v[84:87]
    ds_read_b64_tr_b16 v[34:35], v10 offset:49920
    s_waitcnt lgkmcnt(9)
    v_mfma_f32_16x16x32_bf16 v[64:67], v[40:43], v[200:203], v[64:67]
    ds_read_b64_tr_b16 v[36:37], v11 offset:49152
    v_mfma_f32_16x16x32_bf16 v[88:91], v[40:43], v[204:207], v[88:91]
    ds_read_b64_tr_b16 v[38:39], v11 offset:49920
    s_waitcnt lgkmcnt(8)
    v_mfma_f32_16x16x32_bf16 v[68:71], v[44:47], v[200:203], v[68:71]
    ds_read_b64_tr_b16 v[40:41], v12 offset:49152
    buffer_load_dwordx4 a[56:59], v1, s[40:43], s69 offen offset:0 sc1
    v_mfma_f32_16x16x32_bf16 v[92:95], v[44:47], v[204:207], v[92:95]
    ds_read_b64_tr_b16 v[42:43], v12 offset:49920
    s_waitcnt vmcnt(25)
    s_waitcnt lgkmcnt(6)
    v_mfma_f32_16x16x32_bf16 v[48:51], v[24:27], v[208:211], v[48:51]
    ds_read_b64_tr_b16 v[44:45], v13 offset:49152
    ds_read_b128 a[8:11], v16 offset:1216
    v_mfma_f32_16x16x32_bf16 v[72:75], v[24:27], v[212:215], v[72:75]
    ds_read_b64_tr_b16 v[46:47], v13 offset:49920
    v_mfma_f32_16x16x32_bf16 a[0:3], v[24:27], a[12:15], a[0:3]
    v_mfma_f32_16x16x32_bf16 v[52:55], v[28:31], v[208:211], v[52:55]
    ds_read_b64_tr_b16 v[24:25], v8 offset:55296
    buffer_load_dwordx4 a[60:63], v1, s[40:43], s69 offen offset:1024 sc1
    v_mfma_f32_16x16x32_bf16 v[76:79], v[28:31], v[212:215], v[76:79]
    ds_read_b64_tr_b16 v[26:27], v8 offset:56064
    v_mfma_f32_16x16x32_bf16 a[4:7], v[28:31], a[12:15], a[4:7]
    s_waitcnt lgkmcnt(7)
    v_mfma_f32_16x16x32_bf16 v[56:59], v[32:35], v[208:211], v[56:59]
    ds_read_b64_tr_b16 v[28:29], v9 offset:55296
    v_mfma_f32_16x16x32_bf16 v[80:83], v[32:35], v[212:215], v[80:83]
    ds_read_b64_tr_b16 v[30:31], v9 offset:56064
    v_mfma_f32_16x16x32_bf16 v[60:63], v[36:39], v[208:211], v[60:63]
    ds_read_b64_tr_b16 v[32:33], v10 offset:55296
    buffer_load_dwordx4 a[64:67], v1, s[40:43], s69 offen offset:2048 sc1
    v_mfma_f32_16x16x32_bf16 v[84:87], v[36:39], v[212:215], v[84:87]
    ds_read_b64_tr_b16 v[34:35], v10 offset:56064
    s_waitcnt lgkmcnt(9)
    v_mfma_f32_16x16x32_bf16 v[64:67], v[40:43], v[208:211], v[64:67]
    ds_read_b64_tr_b16 v[36:37], v11 offset:55296
    v_mfma_f32_16x16x32_bf16 v[88:91], v[40:43], v[212:215], v[88:91]
    ds_read_b64_tr_b16 v[38:39], v11 offset:56064
    s_waitcnt lgkmcnt(8)
    v_mfma_f32_16x16x32_bf16 v[68:71], v[44:47], v[208:211], v[68:71]
    ds_read_b64_tr_b16 v[40:41], v12 offset:55296
    buffer_load_dwordx4 a[68:71], v1, s[40:43], s69 offen offset:3072 sc1
    v_mfma_f32_16x16x32_bf16 v[92:95], v[44:47], v[212:215], v[92:95]
    ds_read_b64_tr_b16 v[42:43], v12 offset:56064
    s_waitcnt vmcnt(26)
    s_waitcnt lgkmcnt(6)
    v_mfma_f32_16x16x32_bf16 v[48:51], v[24:27], v[216:219], v[48:51]
    ds_read_b64_tr_b16 v[44:45], v13 offset:55296
    v_mfma_f32_16x16x32_bf16 v[72:75], v[24:27], v[220:223], v[72:75]
    ds_read_b64_tr_b16 v[46:47], v13 offset:56064
    v_mfma_f32_16x16x32_bf16 a[0:3], v[24:27], a[8:11], a[0:3]
    v_mfma_f32_16x16x32_bf16 v[52:55], v[28:31], v[216:219], v[52:55]
    ds_read_b64_tr_b16 v[24:25], v8 offset:0
    buffer_load_dwordx4 a[72:75], v5, s[40:43], s69 offen offset:0 sc1
    s_add_u32 s69, s69, 40960
    v_mfma_f32_16x16x32_bf16 v[76:79], v[28:31], v[220:223], v[76:79]
    ds_read_b64_tr_b16 v[26:27], v8 offset:768
    v_mfma_f32_16x16x32_bf16 a[4:7], v[28:31], a[8:11], a[4:7]
    s_waitcnt lgkmcnt(6)
    v_mfma_f32_16x16x32_bf16 v[56:59], v[32:35], v[216:219], v[56:59]
    ds_read_b64_tr_b16 v[28:29], v9 offset:0
    v_mfma_f32_16x16x32_bf16 v[80:83], v[32:35], v[220:223], v[80:83]
    ds_read_b64_tr_b16 v[30:31], v9 offset:768
    v_mfma_f32_16x16x32_bf16 v[60:63], v[36:39], v[216:219], v[60:63]
    ds_read_b64_tr_b16 v[32:33], v10 offset:0
    buffer_load_dwordx4 a[76:79], v1, s[40:43], s69 offen offset:0 sc1
    v_mfma_f32_16x16x32_bf16 v[84:87], v[36:39], v[220:223], v[84:87]
    ds_read_b64_tr_b16 v[34:35], v10 offset:768
    s_waitcnt lgkmcnt(8)
    v_mfma_f32_16x16x32_bf16 v[64:67], v[40:43], v[216:219], v[64:67]
    ds_read_b64_tr_b16 v[36:37], v11 offset:0
    v_mfma_f32_16x16x32_bf16 v[88:91], v[40:43], v[220:223], v[88:91]
    ds_read_b64_tr_b16 v[38:39], v11 offset:768
    s_waitcnt lgkmcnt(8)
    v_mfma_f32_16x16x32_bf16 v[68:71], v[44:47], v[216:219], v[68:71]
    ds_read_b64_tr_b16 v[40:41], v12 offset:0
    buffer_load_dwordx4 a[80:83], v1, s[40:43], s69 offen offset:1024 sc1
    v_mfma_f32_16x16x32_bf16 v[92:95], v[44:47], v[220:223], v[92:95]
    ds_read_b64_tr_b16 v[42:43], v12 offset:768
    s_waitcnt vmcnt(27)
    s_waitcnt lgkmcnt(6)
    v_mfma_f32_16x16x32_bf16 v[48:51], v[24:27], v[224:227], v[48:51]
    ds_read_b64_tr_b16 v[44:45], v13 offset:0
    s_mov_b32 exec_lo, 0x00030003
    s_mov_b32 exec_hi, 0x00030003
    ds_write_b128 v17, a[0:3]
    ds_write_b128 v17, a[4:7] offset:64
    s_mov_b64 exec, -1
    v_mfma_f32_16x16x32_bf16 v[72:75], v[24:27], v[228:231], v[72:75]
    ds_read_b64_tr_b16 v[46:47], v13 offset:768
    v_mfma_f32_16x16x32_bf16 v[52:55], v[28:31], v[224:227], v[52:55]
    ds_read_b64_tr_b16 v[24:25], v8 offset:6144
    buffer_load_dwordx4 a[84:87], v1, s[40:43], s69 offen offset:2048 sc1
    v_mfma_f32_16x16x32_bf16 v[76:79], v[28:31], v[228:231], v[76:79]
    ds_read_b64_tr_b16 v[26:27], v8 offset:6912
    s_lshl_b32 s86, s58, 7
    s_add_u32 s86, s86, 143360
    v_lshl_add_u32 v20, v3, 4, s86
    s_waitcnt lgkmcnt(8)
    v_mfma_f32_16x16x32_bf16 v[56:59], v[32:35], v[224:227], v[56:59]
    ds_read_b64_tr_b16 v[28:29], v9 offset:6144
    v_mfma_f32_16x16x32_bf16 v[80:83], v[32:35], v[228:231], v[80:83]
    ds_read_b64_tr_b16 v[30:31], v9 offset:6912
    s_lshl_b32 s86, s59, 7
    s_add_u32 s86, s86, 143360
    v_lshl_add_u32 v21, v3, 4, s86
    v_mfma_f32_16x16x32_bf16 v[60:63], v[36:39], v[224:227], v[60:63]
    ds_read_b64_tr_b16 v[32:33], v10 offset:6144
    buffer_load_dwordx4 a[88:91], v1, s[40:43], s69 offen offset:3072 sc1
    v_mfma_f32_16x16x32_bf16 v[84:87], v[36:39], v[228:231], v[84:87]
    ds_read_b64_tr_b16 v[34:35], v10 offset:6912
    s_waitcnt lgkmcnt(10)
    v_mfma_f32_16x16x32_bf16 v[64:67], v[40:43], v[224:227], v[64:67]
    ds_read_b64_tr_b16 v[36:37], v11 offset:6144
    s_lshl_b32 s86, s60, 7
    s_add_u32 s86, s86, 143360
    v_lshl_add_u32 v22, v3, 4, s86
    v_mfma_f32_16x16x32_bf16 v[88:91], v[40:43], v[228:231], v[88:91]
    ds_read_b64_tr_b16 v[38:39], v11 offset:6912
    s_waitcnt lgkmcnt(8)
    v_mfma_f32_16x16x32_bf16 v[68:71], v[44:47], v[224:227], v[68:71]
    ds_read_b64_tr_b16 v[40:41], v12 offset:6144
    buffer_load_dwordx4 a[92:95], v5, s[40:43], s69 offen offset:0 sc1
    s_add_u32 s69, s69, 40960
    v_mfma_f32_16x16x32_bf16 v[92:95], v[44:47], v[228:231], v[92:95]
    ds_read_b64_tr_b16 v[42:43], v12 offset:6912
    s_waitcnt vmcnt(28)
    s_waitcnt lgkmcnt(6)
    v_mfma_f32_16x16x32_bf16 v[48:51], v[24:27], v[232:235], v[48:51]
    ds_read_b64_tr_b16 v[44:45], v13 offset:6144
    v_mfma_f32_16x16x32_bf16 v[72:75], v[24:27], v[236:239], v[72:75]
    ds_read_b64_tr_b16 v[46:47], v13 offset:6912
    v_mfma_f32_16x16x32_bf16 v[52:55], v[28:31], v[232:235], v[52:55]
    ds_read_b64_tr_b16 v[24:25], v8 offset:12288
    buffer_load_dwordx4 a[96:99], v1, s[40:43], s69 offen offset:0 sc1
    v_mfma_f32_16x16x32_bf16 v[76:79], v[28:31], v[236:239], v[76:79]
    ds_read_b64_tr_b16 v[26:27], v8 offset:13056
    s_waitcnt lgkmcnt(6)
    v_mfma_f32_16x16x32_bf16 v[56:59], v[32:35], v[232:235], v[56:59]
    ds_read_b64_tr_b16 v[28:29], v9 offset:12288
    v_mfma_f32_16x16x32_bf16 v[80:83], v[32:35], v[236:239], v[80:83]
    ds_read_b64_tr_b16 v[30:31], v9 offset:13056
    v_mfma_f32_16x16x32_bf16 v[60:63], v[36:39], v[232:235], v[60:63]
    ds_read_b64_tr_b16 v[32:33], v10 offset:12288
    buffer_load_dwordx4 a[100:103], v1, s[40:43], s69 offen offset:1024 sc1
    v_mfma_f32_16x16x32_bf16 v[84:87], v[36:39], v[236:239], v[84:87]
    ds_read_b64_tr_b16 v[34:35], v10 offset:13056
    s_waitcnt lgkmcnt(8)
    v_mfma_f32_16x16x32_bf16 v[64:67], v[40:43], v[232:235], v[64:67]
    ds_read_b64_tr_b16 v[36:37], v11 offset:12288
    v_mfma_f32_16x16x32_bf16 v[88:91], v[40:43], v[236:239], v[88:91]
    ds_read_b64_tr_b16 v[38:39], v11 offset:13056
    s_waitcnt lgkmcnt(8)
    v_mfma_f32_16x16x32_bf16 v[68:71], v[44:47], v[232:235], v[68:71]
    ds_read_b64_tr_b16 v[40:41], v12 offset:12288
    buffer_load_dwordx4 a[104:107], v1, s[40:43], s69 offen offset:2048 sc1
    v_mfma_f32_16x16x32_bf16 v[92:95], v[44:47], v[236:239], v[92:95]
    ds_read_b64_tr_b16 v[42:43], v12 offset:13056
    s_barrier
    s_waitcnt vmcnt(29)
    s_waitcnt lgkmcnt(6)
    v_mfma_f32_16x16x32_bf16 v[48:51], v[24:27], v[240:243], v[48:51]
    ds_read_b64_tr_b16 v[44:45], v13 offset:12288
    ds_read_b128 v[96:99], v20 offset:0
    v_mfma_f32_16x16x32_bf16 v[72:75], v[24:27], v[244:247], v[72:75]
    ds_read_b64_tr_b16 v[46:47], v13 offset:13056
    ds_read_b128 v[100:103], v20 offset:64
    v_mfma_f32_16x16x32_bf16 v[52:55], v[28:31], v[240:243], v[52:55]
    ds_read_b64_tr_b16 v[24:25], v8 offset:18432
    buffer_load_dwordx4 a[108:111], v1, s[40:43], s69 offen offset:3072 sc1
    v_mfma_f32_16x16x32_bf16 v[76:79], v[28:31], v[244:247], v[76:79]
    ds_read_b64_tr_b16 v[26:27], v8 offset:19200
    s_waitcnt lgkmcnt(8)
    v_mfma_f32_16x16x32_bf16 v[56:59], v[32:35], v[240:243], v[56:59]
    ds_read_b64_tr_b16 v[28:29], v9 offset:18432
    ds_read_b128 v[104:107], v21 offset:0
    v_mfma_f32_16x16x32_bf16 v[80:83], v[32:35], v[244:247], v[80:83]
    ds_read_b64_tr_b16 v[30:31], v9 offset:19200
    ds_read_b128 v[108:111], v21 offset:64
    v_mfma_f32_16x16x32_bf16 v[60:63], v[36:39], v[240:243], v[60:63]
    ds_read_b64_tr_b16 v[32:33], v10 offset:18432
    buffer_load_dwordx4 a[112:115], v5, s[40:43], s69 offen offset:0 sc1
    s_add_u32 s69, s69, 40960
    v_mfma_f32_16x16x32_bf16 v[84:87], v[36:39], v[244:247], v[84:87]
    ds_read_b64_tr_b16 v[34:35], v10 offset:19200
    s_waitcnt lgkmcnt(12)
    v_mfma_f32_16x16x32_bf16 v[64:67], v[40:43], v[240:243], v[64:67]
    ds_read_b64_tr_b16 v[36:37], v11 offset:18432
    ds_read_b128 v[112:115], v22 offset:0
    v_mfma_f32_16x16x32_bf16 v[88:91], v[40:43], v[244:247], v[88:91]
    ds_read_b64_tr_b16 v[38:39], v11 offset:19200
    ds_read_b128 v[116:119], v22 offset:64
    s_waitcnt lgkmcnt(13)
    v_mfma_f32_16x16x32_bf16 v[68:71], v[44:47], v[240:243], v[68:71]
    ds_read_b64_tr_b16 v[40:41], v12 offset:18432
    buffer_load_dwordx4 a[116:119], v1, s[40:43], s69 offen offset:0 sc1
    v_mfma_f32_16x16x32_bf16 v[92:95], v[44:47], v[244:247], v[92:95]
    ds_read_b64_tr_b16 v[42:43], v12 offset:19200
    s_waitcnt vmcnt(30)
    s_waitcnt lgkmcnt(9)
    v_mfma_f32_16x16x32_bf16 v[48:51], v[24:27], v[248:251], v[48:51]
    ds_read_b64_tr_b16 v[44:45], v13 offset:18432
    ds_read_b128 v[120:123], v20 offset:384
    v_mfma_f32_16x16x32_bf16 v[72:75], v[24:27], v[252:255], v[72:75]
    ds_read_b64_tr_b16 v[46:47], v13 offset:19200
    ds_read_b128 v[124:127], v20 offset:448
    v_mfma_f32_16x16x32_bf16 v[52:55], v[28:31], v[248:251], v[52:55]
    buffer_load_dwordx4 a[120:123], v1, s[40:43], s69 offen offset:1024 sc1
    v_mfma_f32_16x16x32_bf16 v[76:79], v[28:31], v[252:255], v[76:79]
    s_waitcnt lgkmcnt(7)
    v_mfma_f32_16x16x32_bf16 v[56:59], v[32:35], v[248:251], v[56:59]
    ds_read_b128 v[128:131], v21 offset:384
    v_mfma_f32_16x16x32_bf16 v[80:83], v[32:35], v[252:255], v[80:83]
    ds_read_b128 v[132:135], v21 offset:448
    v_mfma_f32_16x16x32_bf16 v[60:63], v[36:39], v[248:251], v[60:63]
    buffer_load_dwordx4 a[124:127], v1, s[40:43], s69 offen offset:2048 sc1
    v_mfma_f32_16x16x32_bf16 v[84:87], v[36:39], v[252:255], v[84:87]
    s_waitcnt lgkmcnt(6)
    v_mfma_f32_16x16x32_bf16 v[64:67], v[40:43], v[248:251], v[64:67]
    ds_read_b128 v[136:139], v22 offset:384
    v_mfma_f32_16x16x32_bf16 v[88:91], v[40:43], v[252:255], v[88:91]
    ds_read_b128 v[140:143], v22 offset:448
    s_waitcnt lgkmcnt(5)
    v_mfma_f32_16x16x32_bf16 v[68:71], v[44:47], v[248:251], v[68:71]
    buffer_load_dwordx4 a[128:131], v1, s[40:43], s69 offen offset:3072 sc1
    v_mfma_f32_16x16x32_bf16 v[92:95], v[44:47], v[252:255], v[92:95]
    s_waitcnt vmcnt(21)
    v_pk_add_f32 v[16:17], v[184:185], v[186:187]
    v_pk_add_f32 v[20:21], v[188:189], v[190:191]
    v_mov_b32 v24, v16
    v_mov_b32 v25, v17
    v_mov_b32 v26, v20
    v_mov_b32 v27, v21
    v_permlane32_swap_b32 v16, v24
    v_permlane32_swap_b32 v17, v25
    v_permlane32_swap_b32 v20, v26
    v_permlane32_swap_b32 v21, v27
    v_add_f32 v16, v16, v24
    v_add_f32 v17, v17, v25
    v_add_f32 v20, v20, v26
    v_add_f32 v21, v21, v27
    v_mov_b32 v24, v16
    v_mov_b32 v25, v17
    v_mov_b32 v26, v20
    v_mov_b32 v27, v21
    v_permlane16_swap_b32 v16, v24
    v_permlane16_swap_b32 v17, v25
    v_permlane16_swap_b32 v20, v26
    v_permlane16_swap_b32 v21, v27
    v_add_f32 v16, v16, v24
    v_add_f32 v17, v17, v25
    v_add_f32 v20, v20, v26
    v_add_f32 v21, v21, v27
    s_mov_b32 s93, 0x3acccccd
    v_mul_f32 v16, 0x3acccccd, v16
    v_mul_f32 v18, v16, v16
    v_fma_f32 v17, v17, s93, -v18
    v_max_f32 v17, 0, v17
    v_add_f32 v17, 0x3727c5ac, v17
    v_rsq_f32 v17, v17
    v_mul_f32 v20, 0x3acccccd, v20
    v_mul_f32 v22, v20, v20
    v_fma_f32 v21, v21, s93, -v22
    v_max_f32 v21, 0, v21
    v_add_f32 v21, 0x3727c5ac, v21
    v_rsq_f32 v21, v21
    v_and_b32 v13, 1, v3
    v_lshrrev_b32 v12, 1, v3
    v_lshl_add_u32 v12, v13, 1, v12
    v_lshlrev_b32 v13, 4, v2
    v_lshl_add_u32 v13, v12, 8, v13
    v_add_u32 v12, 49152, v13
    s_mul_i32 s88, s91, 98304
    s_mul_i32 s87, s5, 3072
    s_add_u32 s88, s88, s87
    s_add_u32 s88, s88, 0x828000
    s_lshl_b32 s58, s58, 10
    s_add_u32 s58, s58, s88
    s_lshl_b32 s59, s59, 10
    s_add_u32 s59, s59, s88
    s_lshl_b32 s60, s60, 10
    s_add_u32 s60, s60, s88
    s_mov_b32 s86, 0xbfb8aa3b
    s_mov_b32 s87, s86
    s_waitcnt lgkmcnt(0)
    v_pk_fma_f32 v[48:49], v[96:97], v[16:17], v[48:49] op_sel_hi:[1,0,1] neg_lo:[0,1,0] neg_hi:[0,1,0]
    v_pk_fma_f32 v[50:51], v[98:99], v[16:17], v[50:51] op_sel_hi:[1,0,1] neg_lo:[0,1,0] neg_hi:[0,1,0]
    v_pk_fma_f32 v[52:53], v[100:101], v[16:17], v[52:53] op_sel_hi:[1,0,1] neg_lo:[0,1,0] neg_hi:[0,1,0]
    v_pk_fma_f32 v[54:55], v[102:103], v[16:17], v[54:55] op_sel_hi:[1,0,1] neg_lo:[0,1,0] neg_hi:[0,1,0]
    v_pk_fma_f32 v[48:49], v[48:49], v[16:17], v[120:121] op_sel:[0,1,0] op_sel_hi:[1,1,1]
    v_pk_fma_f32 v[50:51], v[50:51], v[16:17], v[122:123] op_sel:[0,1,0] op_sel_hi:[1,1,1]
    v_pk_fma_f32 v[52:53], v[52:53], v[16:17], v[124:125] op_sel:[0,1,0] op_sel_hi:[1,1,1]
    v_pk_fma_f32 v[54:55], v[54:55], v[16:17], v[126:127] op_sel:[0,1,0] op_sel_hi:[1,1,1]
    v_pk_mul_f32 v[144:145], v[48:49], s[86:87]
    v_pk_mul_f32 v[146:147], v[50:51], s[86:87]
    v_pk_mul_f32 v[148:149], v[52:53], s[86:87]
    v_pk_mul_f32 v[150:151], v[54:55], s[86:87]
    v_exp_f32 v144, v144
    v_exp_f32 v145, v145
    v_exp_f32 v146, v146
    v_exp_f32 v147, v147
    v_exp_f32 v148, v148
    v_exp_f32 v149, v149
    v_exp_f32 v150, v150
    v_exp_f32 v151, v151
    v_pk_add_f32 v[144:145], v[144:145], 1.0 op_sel_hi:[1,0]
    v_pk_add_f32 v[146:147], v[146:147], 1.0 op_sel_hi:[1,0]
    v_pk_add_f32 v[148:149], v[148:149], 1.0 op_sel_hi:[1,0]
    v_pk_add_f32 v[150:151], v[150:151], 1.0 op_sel_hi:[1,0]
    v_rcp_f32 v144, v144
    v_rcp_f32 v145, v145
    v_rcp_f32 v146, v146
    v_rcp_f32 v147, v147
    v_rcp_f32 v148, v148
    v_rcp_f32 v149, v149
    v_rcp_f32 v150, v150
    v_rcp_f32 v151, v151
    v_pk_mul_f32 v[48:49], v[48:49], v[144:145]
    v_pk_mul_f32 v[50:51], v[50:51], v[146:147]
    v_pk_mul_f32 v[52:53], v[52:53], v[148:149]
    v_pk_mul_f32 v[54:55], v[54:55], v[150:151]
    v_cvt_pk_bf16_f32 v160, v48, v49
    v_cvt_pk_bf16_f32 v161, v50, v51
    v_cvt_pk_bf16_f32 v162, v52, v53
    v_cvt_pk_bf16_f32 v163, v54, v55
    s_nop 0
    v_permlane16_swap_b32 v160, v162
    v_permlane16_swap_b32 v161, v163
    buffer_store_dwordx4 v[160:163], v13, s[40:43], s58 offen sc1
    buffer_load_dwordx4 a[132:135], v5, s[40:43], s69 offen offset:0 sc1
    s_add_u32 s69, s69, 40960
    buffer_load_dwordx4 a[136:139], v1, s[40:43], s69 offen offset:0 sc1
    buffer_load_dwordx4 a[140:143], v1, s[40:43], s69 offen offset:1024 sc1
    buffer_load_dwordx4 a[144:147], v1, s[40:43], s69 offen offset:2048 sc1
    v_pk_fma_f32 v[56:57], v[104:105], v[16:17], v[56:57] op_sel_hi:[1,0,1] neg_lo:[0,1,0] neg_hi:[0,1,0]
    v_pk_fma_f32 v[58:59], v[106:107], v[16:17], v[58:59] op_sel_hi:[1,0,1] neg_lo:[0,1,0] neg_hi:[0,1,0]
    v_pk_fma_f32 v[60:61], v[108:109], v[16:17], v[60:61] op_sel_hi:[1,0,1] neg_lo:[0,1,0] neg_hi:[0,1,0]
    v_pk_fma_f32 v[62:63], v[110:111], v[16:17], v[62:63] op_sel_hi:[1,0,1] neg_lo:[0,1,0] neg_hi:[0,1,0]
    v_pk_fma_f32 v[56:57], v[56:57], v[16:17], v[128:129] op_sel:[0,1,0] op_sel_hi:[1,1,1]
    v_pk_fma_f32 v[58:59], v[58:59], v[16:17], v[130:131] op_sel:[0,1,0] op_sel_hi:[1,1,1]
    v_pk_fma_f32 v[60:61], v[60:61], v[16:17], v[132:133] op_sel:[0,1,0] op_sel_hi:[1,1,1]
    v_pk_fma_f32 v[62:63], v[62:63], v[16:17], v[134:135] op_sel:[0,1,0] op_sel_hi:[1,1,1]
    v_pk_mul_f32 v[152:153], v[56:57], s[86:87]
    v_pk_mul_f32 v[154:155], v[58:59], s[86:87]
    v_pk_mul_f32 v[156:157], v[60:61], s[86:87]
    v_pk_mul_f32 v[158:159], v[62:63], s[86:87]
    v_exp_f32 v152, v152
    v_exp_f32 v153, v153
    v_exp_f32 v154, v154
    v_exp_f32 v155, v155
    v_exp_f32 v156, v156
    v_exp_f32 v157, v157
    v_exp_f32 v158, v158
    v_exp_f32 v159, v159
    v_pk_add_f32 v[152:153], v[152:153], 1.0 op_sel_hi:[1,0]
    v_pk_add_f32 v[154:155], v[154:155], 1.0 op_sel_hi:[1,0]
    v_pk_add_f32 v[156:157], v[156:157], 1.0 op_sel_hi:[1,0]
    v_pk_add_f32 v[158:159], v[158:159], 1.0 op_sel_hi:[1,0]
    v_rcp_f32 v152, v152
    v_rcp_f32 v153, v153
    v_rcp_f32 v154, v154
    v_rcp_f32 v155, v155
    v_rcp_f32 v156, v156
    v_rcp_f32 v157, v157
    v_rcp_f32 v158, v158
    v_rcp_f32 v159, v159
    v_pk_mul_f32 v[56:57], v[56:57], v[152:153]
    v_pk_mul_f32 v[58:59], v[58:59], v[154:155]
    v_pk_mul_f32 v[60:61], v[60:61], v[156:157]
    v_pk_mul_f32 v[62:63], v[62:63], v[158:159]
    v_cvt_pk_bf16_f32 v164, v56, v57
    v_cvt_pk_bf16_f32 v165, v58, v59
    v_cvt_pk_bf16_f32 v166, v60, v61
    v_cvt_pk_bf16_f32 v167, v62, v63
    s_nop 0
    v_permlane16_swap_b32 v164, v166
    v_permlane16_swap_b32 v165, v167
    buffer_store_dwordx4 v[164:167], v13, s[40:43], s59 offen sc1
    buffer_load_dwordx4 a[148:151], v1, s[40:43], s69 offen offset:3072 sc1
    buffer_load_dwordx4 a[152:155], v5, s[40:43], s69 offen offset:0 sc1
    s_add_u32 s69, s69, 40960
    buffer_load_dwordx4 a[156:159], v1, s[40:43], s69 offen offset:0 sc1
    buffer_load_dwordx4 a[160:163], v1, s[40:43], s69 offen offset:1024 sc1
    v_pk_fma_f32 v[64:65], v[112:113], v[16:17], v[64:65] op_sel_hi:[1,0,1] neg_lo:[0,1,0] neg_hi:[0,1,0]
    v_pk_fma_f32 v[66:67], v[114:115], v[16:17], v[66:67] op_sel_hi:[1,0,1] neg_lo:[0,1,0] neg_hi:[0,1,0]
    v_pk_fma_f32 v[68:69], v[116:117], v[16:17], v[68:69] op_sel_hi:[1,0,1] neg_lo:[0,1,0] neg_hi:[0,1,0]
    v_pk_fma_f32 v[70:71], v[118:119], v[16:17], v[70:71] op_sel_hi:[1,0,1] neg_lo:[0,1,0] neg_hi:[0,1,0]
    v_pk_fma_f32 v[64:65], v[64:65], v[16:17], v[136:137] op_sel:[0,1,0] op_sel_hi:[1,1,1]
    v_pk_fma_f32 v[66:67], v[66:67], v[16:17], v[138:139] op_sel:[0,1,0] op_sel_hi:[1,1,1]
    v_pk_fma_f32 v[68:69], v[68:69], v[16:17], v[140:141] op_sel:[0,1,0] op_sel_hi:[1,1,1]
    v_pk_fma_f32 v[70:71], v[70:71], v[16:17], v[142:143] op_sel:[0,1,0] op_sel_hi:[1,1,1]
    v_pk_mul_f32 v[144:145], v[64:65], s[86:87]
    v_pk_mul_f32 v[146:147], v[66:67], s[86:87]
    v_pk_mul_f32 v[148:149], v[68:69], s[86:87]
    v_pk_mul_f32 v[150:151], v[70:71], s[86:87]
    v_exp_f32 v144, v144
    v_exp_f32 v145, v145
    v_exp_f32 v146, v146
    v_exp_f32 v147, v147
    v_exp_f32 v148, v148
    v_exp_f32 v149, v149
    v_exp_f32 v150, v150
    v_exp_f32 v151, v151
    v_pk_add_f32 v[144:145], v[144:145], 1.0 op_sel_hi:[1,0]
    v_pk_add_f32 v[146:147], v[146:147], 1.0 op_sel_hi:[1,0]
    v_pk_add_f32 v[148:149], v[148:149], 1.0 op_sel_hi:[1,0]
    v_pk_add_f32 v[150:151], v[150:151], 1.0 op_sel_hi:[1,0]
    v_rcp_f32 v144, v144
    v_rcp_f32 v145, v145
    v_rcp_f32 v146, v146
    v_rcp_f32 v147, v147
    v_rcp_f32 v148, v148
    v_rcp_f32 v149, v149
    v_rcp_f32 v150, v150
    v_rcp_f32 v151, v151
    v_pk_mul_f32 v[64:65], v[64:65], v[144:145]
    v_pk_mul_f32 v[66:67], v[66:67], v[146:147]
    v_pk_mul_f32 v[68:69], v[68:69], v[148:149]
    v_pk_mul_f32 v[70:71], v[70:71], v[150:151]
    v_cvt_pk_bf16_f32 v168, v64, v65
    v_cvt_pk_bf16_f32 v169, v66, v67
    v_cvt_pk_bf16_f32 v170, v68, v69
    v_cvt_pk_bf16_f32 v171, v70, v71
    s_nop 0
    v_permlane16_swap_b32 v168, v170
    v_permlane16_swap_b32 v169, v171
    buffer_store_dwordx4 v[168:171], v13, s[40:43], s60 offen sc1
    v_pk_fma_f32 v[72:73], v[96:97], v[20:21], v[72:73] op_sel_hi:[1,0,1] neg_lo:[0,1,0] neg_hi:[0,1,0]
    v_pk_fma_f32 v[74:75], v[98:99], v[20:21], v[74:75] op_sel_hi:[1,0,1] neg_lo:[0,1,0] neg_hi:[0,1,0]
    v_pk_fma_f32 v[76:77], v[100:101], v[20:21], v[76:77] op_sel_hi:[1,0,1] neg_lo:[0,1,0] neg_hi:[0,1,0]
    v_pk_fma_f32 v[78:79], v[102:103], v[20:21], v[78:79] op_sel_hi:[1,0,1] neg_lo:[0,1,0] neg_hi:[0,1,0]
    v_pk_fma_f32 v[72:73], v[72:73], v[20:21], v[120:121] op_sel:[0,1,0] op_sel_hi:[1,1,1]
    v_pk_fma_f32 v[74:75], v[74:75], v[20:21], v[122:123] op_sel:[0,1,0] op_sel_hi:[1,1,1]
    v_pk_fma_f32 v[76:77], v[76:77], v[20:21], v[124:125] op_sel:[0,1,0] op_sel_hi:[1,1,1]
    v_pk_fma_f32 v[78:79], v[78:79], v[20:21], v[126:127] op_sel:[0,1,0] op_sel_hi:[1,1,1]
    v_pk_mul_f32 v[152:153], v[72:73], s[86:87]
    v_pk_mul_f32 v[154:155], v[74:75], s[86:87]
    v_pk_mul_f32 v[156:157], v[76:77], s[86:87]
    v_pk_mul_f32 v[158:159], v[78:79], s[86:87]
    v_exp_f32 v152, v152
    v_exp_f32 v153, v153
    v_exp_f32 v154, v154
    v_exp_f32 v155, v155
    v_exp_f32 v156, v156
    v_exp_f32 v157, v157
    v_exp_f32 v158, v158
    v_exp_f32 v159, v159
    v_pk_add_f32 v[152:153], v[152:153], 1.0 op_sel_hi:[1,0]
    v_pk_add_f32 v[154:155], v[154:155], 1.0 op_sel_hi:[1,0]
    v_pk_add_f32 v[156:157], v[156:157], 1.0 op_sel_hi:[1,0]
    v_pk_add_f32 v[158:159], v[158:159], 1.0 op_sel_hi:[1,0]
    v_rcp_f32 v152, v152
    v_rcp_f32 v153, v153
    v_rcp_f32 v154, v154
    v_rcp_f32 v155, v155
    v_rcp_f32 v156, v156
    v_rcp_f32 v157, v157
    v_rcp_f32 v158, v158
    v_rcp_f32 v159, v159
    v_pk_mul_f32 v[72:73], v[72:73], v[152:153]
    v_pk_mul_f32 v[74:75], v[74:75], v[154:155]
    v_pk_mul_f32 v[76:77], v[76:77], v[156:157]
    v_pk_mul_f32 v[78:79], v[78:79], v[158:159]
    v_cvt_pk_bf16_f32 v172, v72, v73
    v_cvt_pk_bf16_f32 v173, v74, v75
    v_cvt_pk_bf16_f32 v174, v76, v77
    v_cvt_pk_bf16_f32 v175, v78, v79
    s_nop 0
    v_permlane16_swap_b32 v172, v174
    v_permlane16_swap_b32 v173, v175
    buffer_store_dwordx4 v[172:175], v12, s[40:43], s58 offen sc1
    v_pk_fma_f32 v[80:81], v[104:105], v[20:21], v[80:81] op_sel_hi:[1,0,1] neg_lo:[0,1,0] neg_hi:[0,1,0]
    v_pk_fma_f32 v[82:83], v[106:107], v[20:21], v[82:83] op_sel_hi:[1,0,1] neg_lo:[0,1,0] neg_hi:[0,1,0]
    v_pk_fma_f32 v[84:85], v[108:109], v[20:21], v[84:85] op_sel_hi:[1,0,1] neg_lo:[0,1,0] neg_hi:[0,1,0]
    v_pk_fma_f32 v[86:87], v[110:111], v[20:21], v[86:87] op_sel_hi:[1,0,1] neg_lo:[0,1,0] neg_hi:[0,1,0]
    v_pk_fma_f32 v[80:81], v[80:81], v[20:21], v[128:129] op_sel:[0,1,0] op_sel_hi:[1,1,1]
    v_pk_fma_f32 v[82:83], v[82:83], v[20:21], v[130:131] op_sel:[0,1,0] op_sel_hi:[1,1,1]
    v_pk_fma_f32 v[84:85], v[84:85], v[20:21], v[132:133] op_sel:[0,1,0] op_sel_hi:[1,1,1]
    v_pk_fma_f32 v[86:87], v[86:87], v[20:21], v[134:135] op_sel:[0,1,0] op_sel_hi:[1,1,1]
    v_pk_mul_f32 v[144:145], v[80:81], s[86:87]
    v_pk_mul_f32 v[146:147], v[82:83], s[86:87]
    v_pk_mul_f32 v[148:149], v[84:85], s[86:87]
    v_pk_mul_f32 v[150:151], v[86:87], s[86:87]
    v_exp_f32 v144, v144
    v_exp_f32 v145, v145
    v_exp_f32 v146, v146
    v_exp_f32 v147, v147
    v_exp_f32 v148, v148
    v_exp_f32 v149, v149
    v_exp_f32 v150, v150
    v_exp_f32 v151, v151
    v_pk_add_f32 v[144:145], v[144:145], 1.0 op_sel_hi:[1,0]
    v_pk_add_f32 v[146:147], v[146:147], 1.0 op_sel_hi:[1,0]
    v_pk_add_f32 v[148:149], v[148:149], 1.0 op_sel_hi:[1,0]
    v_pk_add_f32 v[150:151], v[150:151], 1.0 op_sel_hi:[1,0]
    v_rcp_f32 v144, v144
    v_rcp_f32 v145, v145
    v_rcp_f32 v146, v146
    v_rcp_f32 v147, v147
    v_rcp_f32 v148, v148
    v_rcp_f32 v149, v149
    v_rcp_f32 v150, v150
    v_rcp_f32 v151, v151
    v_pk_mul_f32 v[80:81], v[80:81], v[144:145]
    v_pk_mul_f32 v[82:83], v[82:83], v[146:147]
    v_pk_mul_f32 v[84:85], v[84:85], v[148:149]
    v_pk_mul_f32 v[86:87], v[86:87], v[150:151]
    v_cvt_pk_bf16_f32 v176, v80, v81
    v_cvt_pk_bf16_f32 v177, v82, v83
    v_cvt_pk_bf16_f32 v178, v84, v85
    v_cvt_pk_bf16_f32 v179, v86, v87
    s_nop 0
    v_permlane16_swap_b32 v176, v178
    v_permlane16_swap_b32 v177, v179
    buffer_store_dwordx4 v[176:179], v12, s[40:43], s59 offen sc1
    v_pk_fma_f32 v[88:89], v[112:113], v[20:21], v[88:89] op_sel_hi:[1,0,1] neg_lo:[0,1,0] neg_hi:[0,1,0]
    v_pk_fma_f32 v[90:91], v[114:115], v[20:21], v[90:91] op_sel_hi:[1,0,1] neg_lo:[0,1,0] neg_hi:[0,1,0]
    v_pk_fma_f32 v[92:93], v[116:117], v[20:21], v[92:93] op_sel_hi:[1,0,1] neg_lo:[0,1,0] neg_hi:[0,1,0]
    v_pk_fma_f32 v[94:95], v[118:119], v[20:21], v[94:95] op_sel_hi:[1,0,1] neg_lo:[0,1,0] neg_hi:[0,1,0]
    v_pk_fma_f32 v[88:89], v[88:89], v[20:21], v[136:137] op_sel:[0,1,0] op_sel_hi:[1,1,1]
    v_pk_fma_f32 v[90:91], v[90:91], v[20:21], v[138:139] op_sel:[0,1,0] op_sel_hi:[1,1,1]
    v_pk_fma_f32 v[92:93], v[92:93], v[20:21], v[140:141] op_sel:[0,1,0] op_sel_hi:[1,1,1]
    v_pk_fma_f32 v[94:95], v[94:95], v[20:21], v[142:143] op_sel:[0,1,0] op_sel_hi:[1,1,1]
    v_pk_mul_f32 v[152:153], v[88:89], s[86:87]
    v_pk_mul_f32 v[154:155], v[90:91], s[86:87]
    v_pk_mul_f32 v[156:157], v[92:93], s[86:87]
    v_pk_mul_f32 v[158:159], v[94:95], s[86:87]
    v_exp_f32 v152, v152
    v_exp_f32 v153, v153
    v_exp_f32 v154, v154
    v_exp_f32 v155, v155
    v_exp_f32 v156, v156
    v_exp_f32 v157, v157
    v_exp_f32 v158, v158
    v_exp_f32 v159, v159
    v_pk_add_f32 v[152:153], v[152:153], 1.0 op_sel_hi:[1,0]
    v_pk_add_f32 v[154:155], v[154:155], 1.0 op_sel_hi:[1,0]
    v_pk_add_f32 v[156:157], v[156:157], 1.0 op_sel_hi:[1,0]
    v_pk_add_f32 v[158:159], v[158:159], 1.0 op_sel_hi:[1,0]
    v_rcp_f32 v152, v152
    v_rcp_f32 v153, v153
    v_rcp_f32 v154, v154
    v_rcp_f32 v155, v155
    v_rcp_f32 v156, v156
    v_rcp_f32 v157, v157
    v_rcp_f32 v158, v158
    v_rcp_f32 v159, v159
    v_pk_mul_f32 v[88:89], v[88:89], v[152:153]
    v_pk_mul_f32 v[90:91], v[90:91], v[154:155]
    v_pk_mul_f32 v[92:93], v[92:93], v[156:157]
    v_pk_mul_f32 v[94:95], v[94:95], v[158:159]
    v_cvt_pk_bf16_f32 v180, v88, v89
    v_cvt_pk_bf16_f32 v181, v90, v91
    v_cvt_pk_bf16_f32 v182, v92, v93
    v_cvt_pk_bf16_f32 v183, v94, v95
    s_nop 0
    v_permlane16_swap_b32 v180, v182
    v_permlane16_swap_b32 v181, v183
    buffer_store_dwordx4 v[180:183], v12, s[40:43], s60 offen sc1
    s_lshl_b32 s86, s7, 7
    s_add_u32 s86, s86, 0x12000
    s_waitcnt vmcnt(0)
    s_waitcnt lgkmcnt(0)
    s_barrier
    s_cmp_lg_u32 s3, 0
    s_cbranch_scc1 pub_35
    v_mov_b32 v14, s6
    s_mov_b32 exec_lo, 1
    s_mov_b32 exec_hi, 0
    buffer_store_dword v14, off, s[40:43], s86 sc1
    s_mov_b64 exec, -1
pub_35:
    buffer_load_dwordx4 a[164:167], v1, s[40:43], s69 offen offset:2048 sc1
    buffer_load_dwordx4 a[168:171], v1, s[40:43], s69 offen offset:3072 sc1
    buffer_load_dwordx4 a[172:175], v5, s[40:43], s69 offen offset:0 sc1
    s_add_u32 s69, s69, 40960
    buffer_load_dwordx4 a[176:179], v1, s[40:43], s69 offen offset:0 sc1
    buffer_load_dwordx4 a[180:183], v1, s[40:43], s69 offen offset:1024 sc1
    buffer_load_dwordx4 a[184:187], v1, s[40:43], s69 offen offset:2048 sc1
    buffer_load_dwordx4 a[188:191], v1, s[40:43], s69 offen offset:3072 sc1
    buffer_load_dwordx4 a[192:195], v5, s[40:43], s69 offen offset:0 sc1
    s_add_u32 s69, s69, 40960
    buffer_load_dwordx4 a[196:199], v1, s[40:43], s69 offen offset:0 sc1
    buffer_load_dwordx4 a[200:203], v1, s[40:43], s69 offen offset:1024 sc1
    buffer_load_dwordx4 a[204:207], v1, s[40:43], s69 offen offset:2048 sc1
    buffer_load_dwordx4 a[208:211], v1, s[40:43], s69 offen offset:3072 sc1
    buffer_load_dwordx4 a[212:215], v5, s[40:43], s69 offen offset:0 sc1
    s_add_u32 s69, s69, 40960
    buffer_load_dwordx4 a[216:219], v1, s[40:43], s69 offen offset:0 sc1
    buffer_load_dwordx4 a[220:223], v1, s[40:43], s69 offen offset:1024 sc1
    buffer_load_dwordx4 a[224:227], v1, s[40:43], s69 offen offset:2048 sc1
    buffer_load_dwordx4 a[228:231], v1, s[40:43], s69 offen offset:3072 sc1
    buffer_load_dwordx4 a[232:235], v5, s[40:43], s69 offen offset:0 sc1
    s_add_u32 s69, s69, 40960
    buffer_load_dwordx4 a[236:239], v1, s[40:43], s69 offen offset:0 sc1
    buffer_load_dwordx4 a[240:243], v1, s[40:43], s69 offen offset:1024 sc1
    buffer_load_dwordx4 a[244:247], v1, s[40:43], s69 offen offset:2048 sc1
    buffer_load_dwordx4 a[248:251], v1, s[40:43], s69 offen offset:3072 sc1
    buffer_load_dwordx4 a[252:255], v5, s[40:43], s69 offen offset:0 sc1
    s_add_u32 s69, s69, 40960
    ds_read_b128 v[160:163], v4 offset:5120
    ds_read_b128 v[164:167], v4 offset:5184
    ds_read_b128 v[168:171], v4 offset:5248
    ds_read_b128 v[172:175], v4 offset:5312
    ds_read_b128 v[176:179], v4 offset:5376
    ds_read_b128 v[180:183], v7 offset:0
    ds_read_b128 v[184:187], v7 offset:1024
    ds_read_b128 v[188:191], v7 offset:2048
    ds_read_b128 v[192:195], v7 offset:3072
    ds_read_b128 v[196:199], v7 offset:4096
    v_and_b32 v13, 1, v3
    v_lshrrev_b32 v14, 1, v3
    v_lshl_add_u32 v14, v13, 1, v14
    v_lshl_add_u32 v6, v14, 4, v6
    v_and_b32 v8, 3, v0
    v_lshlrev_b32 v8, 7, v8
    s_lshl2_add_u32 s86, s4, s3
    s_lshl_b32 s86, s86, 9
    s_add_u32 s86, s86, 0x12000
    s_lshl1_add_u32 s87, s4, s30
    s_mul_i32 s87, s87, 196608
    s_mul_i32 s92, s3, 12288
    s_add_u32 s87, s87, s92
    s_add_u32 s87, s87, 0x828000
    s_xor_b32 s92, s3, 0
    s_mul_i32 s88, s92, 49152
    s_add_u32 s88, s88, s87
    s_xor_b32 s92, s3, 1
    s_mul_i32 s89, s92, 49152
    s_add_u32 s89, s89, s87
    s_mul_i32 s92, s92, 15360
    s_add_u32 s92, s92, 0
    v_add_u32 v9, s92, v1
    s_xor_b32 s92, s3, 2
    s_mul_i32 s90, s92, 49152
    s_add_u32 s90, s90, s87
    s_mul_i32 s92, s92, 15360
    s_add_u32 s92, s92, 5120
    v_add_u32 v10, s92, v1
    s_xor_b32 s92, s3, 3
    s_mul_i32 s91, s92, 49152
    s_add_u32 s91, s91, s87
    s_mul_i32 s92, s92, 15360
    s_add_u32 s92, s92, 10240
    v_add_u32 v11, s92, v1
    s_mul_i32 s92, s3, 15360
    s_add_u32 s92, s92, 0
    v_add_u32 v12, s92, v1
    s_mov_b32 s94, 0x8000
poll_36:
    buffer_load_dword v13, v8, s[40:43], s86 offen sc1
    s_waitcnt vmcnt(0)
    v_cmp_ne_u32 vcc, s6, v13
    s_cbranch_vccz pdone_37
    s_sub_u32 s94, s94, 1
    s_cmp_lg_u32 s94, 0
    s_cbranch_scc1 poll_36
pdone_37:
    buffer_load_dwordx4 v[96:99], v1, s[40:43], s89 offen offset:0 sc1
    buffer_load_dwordx4 v[100:103], v1, s[40:43], s89 offen offset:1024 sc1
    buffer_load_dwordx4 v[104:107], v1, s[40:43], s89 offen offset:2048 sc1
    buffer_load_dwordx4 v[108:111], v1, s[40:43], s89 offen offset:3072 sc1
    buffer_load_dwordx4 v[112:115], v5, s[40:43], s89 offen offset:0 sc1
    buffer_load_dwordx4 v[116:119], v5, s[40:43], s89 offen offset:1024 sc1
    buffer_load_dwordx4 v[120:123], v5, s[40:43], s89 offen offset:2048 sc1
    buffer_load_dwordx4 v[124:127], v5, s[40:43], s89 offen offset:3072 sc1
    s_add_u32 s89, s89, 8192
    buffer_load_dwordx4 v[128:131], v1, s[40:43], s89 offen offset:0 sc1
    buffer_load_dwordx4 v[132:135], v1, s[40:43], s89 offen offset:1024 sc1
    buffer_load_dwordx4 v[136:139], v1, s[40:43], s89 offen offset:2048 sc1
    buffer_load_dwordx4 v[140:143], v1, s[40:43], s89 offen offset:3072 sc1
    s_waitcnt vmcnt(11)
    v_mfma_f32_16x16x32_bf16 v[36:39], a[16:19], v[96:99], 0
    buffer_load_dwordx4 v[144:147], v1, s[40:43], s90 offen offset:0 sc1
    v_mfma_f32_16x16x32_bf16 v[40:43], a[20:23], v[96:99], 0
    v_mfma_f32_16x16x32_bf16 v[44:47], a[24:27], v[96:99], 0
    v_mfma_f32_16x16x32_bf16 v[48:51], a[28:31], v[96:99], 0
    v_mfma_f32_16x16x32_bf16 v[52:55], a[32:35], v[96:99], 0
    s_waitcnt vmcnt(11)
    v_mfma_f32_16x16x32_bf16 v[36:39], a[36:39], v[100:103], v[36:39]
    buffer_load_dwordx4 v[148:151], v1, s[40:43], s90 offen offset:1024 sc1
    v_mfma_f32_16x16x32_bf16 v[40:43], a[40:43], v[100:103], v[40:43]
    v_mfma_f32_16x16x32_bf16 v[44:47], a[44:47], v[100:103], v[44:47]
    v_mfma_f32_16x16x32_bf16 v[48:51], a[48:51], v[100:103], v[48:51]
    v_mfma_f32_16x16x32_bf16 v[52:55], a[52:55], v[100:103], v[52:55]
    s_waitcnt vmcnt(11)
    v_mfma_f32_16x16x32_bf16 v[36:39], a[56:59], v[104:107], v[36:39]
    buffer_load_dwordx4 v[152:155], v1, s[40:43], s90 offen offset:2048 sc1
    v_mfma_f32_16x16x32_bf16 v[40:43], a[60:63], v[104:107], v[40:43]
    v_mfma_f32_16x16x32_bf16 v[44:47], a[64:67], v[104:107], v[44:47]
    v_mfma_f32_16x16x32_bf16 v[48:51], a[68:71], v[104:107], v[48:51]
    v_mfma_f32_16x16x32_bf16 v[52:55], a[72:75], v[104:107], v[52:55]
    s_waitcnt vmcnt(11)
    v_mfma_f32_16x16x32_bf16 v[36:39], a[76:79], v[108:111], v[36:39]
    buffer_load_dwordx4 v[156:159], v1, s[40:43], s90 offen offset:3072 sc1
    v_mfma_f32_16x16x32_bf16 v[40:43], a[80:83], v[108:111], v[40:43]
    v_mfma_f32_16x16x32_bf16 v[44:47], a[84:87], v[108:111], v[44:47]
    v_mfma_f32_16x16x32_bf16 v[48:51], a[88:91], v[108:111], v[48:51]
    v_mfma_f32_16x16x32_bf16 v[52:55], a[92:95], v[108:111], v[52:55]
    s_waitcnt vmcnt(11)
    v_mfma_f32_16x16x32_bf16 v[36:39], a[96:99], v[112:115], v[36:39]
    buffer_load_dwordx4 v[96:99], v5, s[40:43], s90 offen offset:0 sc1
    v_mfma_f32_16x16x32_bf16 v[40:43], a[100:103], v[112:115], v[40:43]
    v_mfma_f32_16x16x32_bf16 v[44:47], a[104:107], v[112:115], v[44:47]
    v_mfma_f32_16x16x32_bf16 v[48:51], a[108:111], v[112:115], v[48:51]
    v_mfma_f32_16x16x32_bf16 v[52:55], a[112:115], v[112:115], v[52:55]
    s_waitcnt vmcnt(11)
    v_mfma_f32_16x16x32_bf16 v[36:39], a[116:119], v[116:119], v[36:39]
    buffer_load_dwordx4 v[100:103], v5, s[40:43], s90 offen offset:1024 sc1
    v_mfma_f32_16x16x32_bf16 v[40:43], a[120:123], v[116:119], v[40:43]
    v_mfma_f32_16x16x32_bf16 v[44:47], a[124:127], v[116:119], v[44:47]
    v_mfma_f32_16x16x32_bf16 v[48:51], a[128:131], v[116:119], v[48:51]
    v_mfma_f32_16x16x32_bf16 v[52:55], a[132:135], v[116:119], v[52:55]
    s_waitcnt vmcnt(11)
    v_mfma_f32_16x16x32_bf16 v[36:39], a[136:139], v[120:123], v[36:39]
    buffer_load_dwordx4 v[104:107], v5, s[40:43], s90 offen offset:2048 sc1
    v_mfma_f32_16x16x32_bf16 v[40:43], a[140:143], v[120:123], v[40:43]
    v_mfma_f32_16x16x32_bf16 v[44:47], a[144:147], v[120:123], v[44:47]
    v_mfma_f32_16x16x32_bf16 v[48:51], a[148:151], v[120:123], v[48:51]
    v_mfma_f32_16x16x32_bf16 v[52:55], a[152:155], v[120:123], v[52:55]
    s_waitcnt vmcnt(11)
    v_mfma_f32_16x16x32_bf16 v[36:39], a[156:159], v[124:127], v[36:39]
    buffer_load_dwordx4 v[108:111], v5, s[40:43], s90 offen offset:3072 sc1
    v_mfma_f32_16x16x32_bf16 v[40:43], a[160:163], v[124:127], v[40:43]
    v_mfma_f32_16x16x32_bf16 v[44:47], a[164:167], v[124:127], v[44:47]
    v_mfma_f32_16x16x32_bf16 v[48:51], a[168:171], v[124:127], v[48:51]
    v_mfma_f32_16x16x32_bf16 v[52:55], a[172:175], v[124:127], v[52:55]
    s_waitcnt vmcnt(11)
    v_mfma_f32_16x16x32_bf16 v[36:39], a[176:179], v[128:131], v[36:39]
    s_add_u32 s90, s90, 8192
    buffer_load_dwordx4 v[112:115], v1, s[40:43], s90 offen offset:0 sc1
    v_mfma_f32_16x16x32_bf16 v[40:43], a[180:183], v[128:131], v[40:43]
    v_mfma_f32_16x16x32_bf16 v[44:47], a[184:187], v[128:131], v[44:47]
    v_mfma_f32_16x16x32_bf16 v[48:51], a[188:191], v[128:131], v[48:51]
    v_mfma_f32_16x16x32_bf16 v[52:55], a[192:195], v[128:131], v[52:55]
    s_waitcnt vmcnt(11)
    v_mfma_f32_16x16x32_bf16 v[36:39], a[196:199], v[132:135], v[36:39]
    buffer_load_dwordx4 v[116:119], v1, s[40:43], s90 offen offset:1024 sc1
    v_mfma_f32_16x16x32_bf16 v[40:43], a[200:203], v[132:135], v[40:43]
    v_mfma_f32_16x16x32_bf16 v[44:47], a[204:207], v[132:135], v[44:47]
    v_mfma_f32_16x16x32_bf16 v[48:51], a[208:211], v[132:135], v[48:51]
    v_mfma_f32_16x16x32_bf16 v[52:55], a[212:215], v[132:135], v[52:55]
    s_waitcnt vmcnt(11)
    v_mfma_f32_16x16x32_bf16 v[36:39], a[216:219], v[136:139], v[36:39]
    buffer_load_dwordx4 v[120:123], v1, s[40:43], s90 offen offset:2048 sc1
    v_mfma_f32_16x16x32_bf16 v[40:43], a[220:223], v[136:139], v[40:43]
    v_mfma_f32_16x16x32_bf16 v[44:47], a[224:227], v[136:139], v[44:47]
    v_mfma_f32_16x16x32_bf16 v[48:51], a[228:231], v[136:139], v[48:51]
    v_mfma_f32_16x16x32_bf16 v[52:55], a[232:235], v[136:139], v[52:55]
    s_waitcnt vmcnt(11)
    v_mfma_f32_16x16x32_bf16 v[36:39], a[236:239], v[140:143], v[36:39]
    buffer_load_dwordx4 v[124:127], v1, s[40:43], s90 offen offset:3072 sc1
    v_mfma_f32_16x16x32_bf16 v[40:43], a[240:243], v[140:143], v[40:43]
    v_mfma_f32_16x16x32_bf16 v[44:47], a[244:247], v[140:143], v[44:47]
    v_mfma_f32_16x16x32_bf16 v[48:51], a[248:251], v[140:143], v[48:51]
    v_mfma_f32_16x16x32_bf16 v[52:55], a[252:255], v[140:143], v[52:55]
    s_waitcnt vmcnt(11)
    v_mfma_f32_16x16x32_bf16 v[56:59], a[16:19], v[144:147], 0
    buffer_load_dwordx4 v[128:131], v1, s[40:43], s91 offen offset:0 sc1
    v_mfma_f32_16x16x32_bf16 v[60:63], a[20:23], v[144:147], 0
    v_mfma_f32_16x16x32_bf16 v[64:67], a[24:27], v[144:147], 0
    v_mfma_f32_16x16x32_bf16 v[68:71], a[28:31], v[144:147], 0
    v_mfma_f32_16x16x32_bf16 v[72:75], a[32:35], v[144:147], 0
    s_waitcnt vmcnt(11)
    v_mfma_f32_16x16x32_bf16 v[56:59], a[36:39], v[148:151], v[56:59]
    buffer_load_dwordx4 v[132:135], v1, s[40:43], s91 offen offset:1024 sc1
    v_mfma_f32_16x16x32_bf16 v[60:63], a[40:43], v[148:151], v[60:63]
    ds_write_b128 v9, v[36:39] offset:0
    v_mfma_f32_16x16x32_bf16 v[64:67], a[44:47], v[148:151], v[64:67]
    v_mfma_f32_16x16x32_bf16 v[68:71], a[48:51], v[148:151], v[68:71]
    ds_write_b128 v9, v[40:43] offset:1024
    v_mfma_f32_16x16x32_bf16 v[72:75], a[52:55], v[148:151], v[72:75]
    s_waitcnt vmcnt(11)
    v_mfma_f32_16x16x32_bf16 v[56:59], a[56:59], v[152:155], v[56:59]
    buffer_load_dwordx4 v[136:139], v1, s[40:43], s91 offen offset:2048 sc1
    v_mfma_f32_16x16x32_bf16 v[60:63], a[60:63], v[152:155], v[60:63]
    ds_write_b128 v9, v[44:47] offset:2048
    v_mfma_f32_16x16x32_bf16 v[64:67], a[64:67], v[152:155], v[64:67]
    v_mfma_f32_16x16x32_bf16 v[68:71], a[68:71], v[152:155], v[68:71]
    ds_write_b128 v9, v[48:51] offset:3072
    v_mfma_f32_16x16x32_bf16 v[72:75], a[72:75], v[152:155], v[72:75]
    s_waitcnt vmcnt(11)
    v_mfma_f32_16x16x32_bf16 v[56:59], a[76:79], v[156:159], v[56:59]
    buffer_load_dwordx4 v[140:143], v1, s[40:43], s91 offen offset:3072 sc1
    v_mfma_f32_16x16x32_bf16 v[60:63], a[80:83], v[156:159], v[60:63]
    ds_write_b128 v9, v[52:55] offset:4096
    v_mfma_f32_16x16x32_bf16 v[64:67], a[84:87], v[156:159], v[64:67]
    v_mfma_f32_16x16x32_bf16 v[68:71], a[88:91], v[156:159], v[68:71]
    v_mfma_f32_16x16x32_bf16 v[72:75], a[92:95], v[156:159], v[72:75]
    s_waitcnt vmcnt(11)
    v_mfma_f32_16x16x32_bf16 v[56:59], a[96:99], v[96:99], v[56:59]
    buffer_load_dwordx4 v[144:147], v5, s[40:43], s91 offen offset:0 sc1
    v_mfma_f32_16x16x32_bf16 v[60:63], a[100:103], v[96:99], v[60:63]
    v_mfma_f32_16x16x32_bf16 v[64:67], a[104:107], v[96:99], v[64:67]
    v_mfma_f32_16x16x32_bf16 v[68:71], a[108:111], v[96:99], v[68:71]
    v_mfma_f32_16x16x32_bf16 v[72:75], a[112:115], v[96:99], v[72:75]
    s_waitcnt vmcnt(11)
    v_mfma_f32_16x16x32_bf16 v[56:59], a[116:119], v[100:103], v[56:59]
    buffer_load_dwordx4 v[148:151], v5, s[40:43], s91 offen offset:1024 sc1
    v_mfma_f32_16x16x32_bf16 v[60:63], a[120:123], v[100:103], v[60:63]
    v_mfma_f32_16x16x32_bf16 v[64:67], a[124:127], v[100:103], v[64:67]
    v_mfma_f32_16x16x32_bf16 v[68:71], a[128:131], v[100:103], v[68:71]
    v_mfma_f32_16x16x32_bf16 v[72:75], a[132:135], v[100:103], v[72:75]
    s_waitcnt vmcnt(11)
    v_mfma_f32_16x16x32_bf16 v[56:59], a[136:139], v[104:107], v[56:59]
    buffer_load_dwordx4 v[152:155], v5, s[40:43], s91 offen offset:2048 sc1
    v_mfma_f32_16x16x32_bf16 v[60:63], a[140:143], v[104:107], v[60:63]
    v_mfma_f32_16x16x32_bf16 v[64:67], a[144:147], v[104:107], v[64:67]
    v_mfma_f32_16x16x32_bf16 v[68:71], a[148:151], v[104:107], v[68:71]
    v_mfma_f32_16x16x32_bf16 v[72:75], a[152:155], v[104:107], v[72:75]
    s_waitcnt vmcnt(11)
    v_mfma_f32_16x16x32_bf16 v[56:59], a[156:159], v[108:111], v[56:59]
    buffer_load_dwordx4 v[156:159], v5, s[40:43], s91 offen offset:3072 sc1
    v_mfma_f32_16x16x32_bf16 v[60:63], a[160:163], v[108:111], v[60:63]
    v_mfma_f32_16x16x32_bf16 v[64:67], a[164:167], v[108:111], v[64:67]
    v_mfma_f32_16x16x32_bf16 v[68:71], a[168:171], v[108:111], v[68:71]
    v_mfma_f32_16x16x32_bf16 v[72:75], a[172:175], v[108:111], v[72:75]
    s_waitcnt vmcnt(11)
    v_mfma_f32_16x16x32_bf16 v[56:59], a[176:179], v[112:115], v[56:59]
    s_add_u32 s91, s91, 8192
    buffer_load_dwordx4 v[96:99], v1, s[40:43], s91 offen offset:0 sc1
    v_mfma_f32_16x16x32_bf16 v[60:63], a[180:183], v[112:115], v[60:63]
    v_mfma_f32_16x16x32_bf16 v[64:67], a[184:187], v[112:115], v[64:67]
    v_mfma_f32_16x16x32_bf16 v[68:71], a[188:191], v[112:115], v[68:71]
    v_mfma_f32_16x16x32_bf16 v[72:75], a[192:195], v[112:115], v[72:75]
    s_waitcnt vmcnt(11)
    v_mfma_f32_16x16x32_bf16 v[56:59], a[196:199], v[116:119], v[56:59]
    buffer_load_dwordx4 v[100:103], v1, s[40:43], s91 offen offset:1024 sc1
    v_mfma_f32_16x16x32_bf16 v[60:63], a[200:203], v[116:119], v[60:63]
    v_mfma_f32_16x16x32_bf16 v[64:67], a[204:207], v[116:119], v[64:67]
    v_mfma_f32_16x16x32_bf16 v[68:71], a[208:211], v[116:119], v[68:71]
    v_mfma_f32_16x16x32_bf16 v[72:75], a[212:215], v[116:119], v[72:75]
    s_waitcnt vmcnt(11)
    v_mfma_f32_16x16x32_bf16 v[56:59], a[216:219], v[120:123], v[56:59]
    buffer_load_dwordx4 v[104:107], v1, s[40:43], s91 offen offset:2048 sc1
    v_mfma_f32_16x16x32_bf16 v[60:63], a[220:223], v[120:123], v[60:63]
    v_mfma_f32_16x16x32_bf16 v[64:67], a[224:227], v[120:123], v[64:67]
    v_mfma_f32_16x16x32_bf16 v[68:71], a[228:231], v[120:123], v[68:71]
    v_mfma_f32_16x16x32_bf16 v[72:75], a[232:235], v[120:123], v[72:75]
    s_waitcnt vmcnt(11)
    v_mfma_f32_16x16x32_bf16 v[56:59], a[236:239], v[124:127], v[56:59]
    buffer_load_dwordx4 v[108:111], v1, s[40:43], s91 offen offset:3072 sc1
    v_mfma_f32_16x16x32_bf16 v[60:63], a[240:243], v[124:127], v[60:63]
    v_mfma_f32_16x16x32_bf16 v[64:67], a[244:247], v[124:127], v[64:67]
    v_mfma_f32_16x16x32_bf16 v[68:71], a[248:251], v[124:127], v[68:71]
    v_mfma_f32_16x16x32_bf16 v[72:75], a[252:255], v[124:127], v[72:75]
    s_waitcnt vmcnt(11)
    v_mfma_f32_16x16x32_bf16 v[76:79], a[16:19], v[128:131], 0
    buffer_load_dwordx4 v[112:115], v1, s[40:43], s88 offen offset:0 sc1
    v_mfma_f32_16x16x32_bf16 v[80:83], a[20:23], v[128:131], 0
    v_mfma_f32_16x16x32_bf16 v[84:87], a[24:27], v[128:131], 0
    v_mfma_f32_16x16x32_bf16 v[88:91], a[28:31], v[128:131], 0
    v_mfma_f32_16x16x32_bf16 v[92:95], a[32:35], v[128:131], 0
    s_waitcnt vmcnt(11)
    v_mfma_f32_16x16x32_bf16 v[76:79], a[36:39], v[132:135], v[76:79]
    buffer_load_dwordx4 v[116:119], v1, s[40:43], s88 offen offset:1024 sc1
    v_mfma_f32_16x16x32_bf16 v[80:83], a[40:43], v[132:135], v[80:83]
    ds_write_b128 v10, v[56:59] offset:0
    v_mfma_f32_16x16x32_bf16 v[84:87], a[44:47], v[132:135], v[84:87]
    v_mfma_f32_16x16x32_bf16 v[88:91], a[48:51], v[132:135], v[88:91]
    ds_write_b128 v10, v[60:63] offset:1024
    v_mfma_f32_16x16x32_bf16 v[92:95], a[52:55], v[132:135], v[92:95]
    s_waitcnt vmcnt(11)
    v_mfma_f32_16x16x32_bf16 v[76:79], a[56:59], v[136:139], v[76:79]
    buffer_load_dwordx4 v[120:123], v1, s[40:43], s88 offen offset:2048 sc1
    v_mfma_f32_16x16x32_bf16 v[80:83], a[60:63], v[136:139], v[80:83]
    ds_write_b128 v10, v[64:67] offset:2048
    v_mfma_f32_16x16x32_bf16 v[84:87], a[64:67], v[136:139], v[84:87]
    v_mfma_f32_16x16x32_bf16 v[88:91], a[68:71], v[136:139], v[88:91]
    ds_write_b128 v10, v[68:71] offset:3072
    v_mfma_f32_16x16x32_bf16 v[92:95], a[72:75], v[136:139], v[92:95]
    s_waitcnt vmcnt(11)
    v_mfma_f32_16x16x32_bf16 v[76:79], a[76:79], v[140:143], v[76:79]
    buffer_load_dwordx4 v[124:127], v1, s[40:43], s88 offen offset:3072 sc1
    v_mfma_f32_16x16x32_bf16 v[80:83], a[80:83], v[140:143], v[80:83]
    ds_write_b128 v10, v[72:75] offset:4096
    v_mfma_f32_16x16x32_bf16 v[84:87], a[84:87], v[140:143], v[84:87]
    v_mfma_f32_16x16x32_bf16 v[88:91], a[88:91], v[140:143], v[88:91]
    v_mfma_f32_16x16x32_bf16 v[92:95], a[92:95], v[140:143], v[92:95]
    s_waitcnt vmcnt(11)
    v_mfma_f32_16x16x32_bf16 v[76:79], a[96:99], v[144:147], v[76:79]
    buffer_load_dwordx4 v[128:131], v5, s[40:43], s88 offen offset:0 sc1
    v_mfma_f32_16x16x32_bf16 v[80:83], a[100:103], v[144:147], v[80:83]
    v_mfma_f32_16x16x32_bf16 v[84:87], a[104:107], v[144:147], v[84:87]
    v_mfma_f32_16x16x32_bf16 v[88:91], a[108:111], v[144:147], v[88:91]
    v_mfma_f32_16x16x32_bf16 v[92:95], a[112:115], v[144:147], v[92:95]
    s_waitcnt vmcnt(11)
    v_mfma_f32_16x16x32_bf16 v[76:79], a[116:119], v[148:151], v[76:79]
    buffer_load_dwordx4 v[132:135], v5, s[40:43], s88 offen offset:1024 sc1
    v_mfma_f32_16x16x32_bf16 v[80:83], a[120:123], v[148:151], v[80:83]
    v_mfma_f32_16x16x32_bf16 v[84:87], a[124:127], v[148:151], v[84:87]
    v_mfma_f32_16x16x32_bf16 v[88:91], a[128:131], v[148:151], v[88:91]
    v_mfma_f32_16x16x32_bf16 v[92:95], a[132:135], v[148:151], v[92:95]
    s_waitcnt vmcnt(11)
    v_mfma_f32_16x16x32_bf16 v[76:79], a[136:139], v[152:155], v[76:79]
    buffer_load_dwordx4 v[136:139], v5, s[40:43], s88 offen offset:2048 sc1
    v_mfma_f32_16x16x32_bf16 v[80:83], a[140:143], v[152:155], v[80:83]
    v_mfma_f32_16x16x32_bf16 v[84:87], a[144:147], v[152:155], v[84:87]
    v_mfma_f32_16x16x32_bf16 v[88:91], a[148:151], v[152:155], v[88:91]
    v_mfma_f32_16x16x32_bf16 v[92:95], a[152:155], v[152:155], v[92:95]
    s_waitcnt vmcnt(11)
    v_mfma_f32_16x16x32_bf16 v[76:79], a[156:159], v[156:159], v[76:79]
    buffer_load_dwordx4 v[140:143], v5, s[40:43], s88 offen offset:3072 sc1
    v_mfma_f32_16x16x32_bf16 v[80:83], a[160:163], v[156:159], v[80:83]
    v_mfma_f32_16x16x32_bf16 v[84:87], a[164:167], v[156:159], v[84:87]
    v_mfma_f32_16x16x32_bf16 v[88:91], a[168:171], v[156:159], v[88:91]
    v_mfma_f32_16x16x32_bf16 v[92:95], a[172:175], v[156:159], v[92:95]
    s_waitcnt vmcnt(11)
    v_mfma_f32_16x16x32_bf16 v[76:79], a[176:179], v[96:99], v[76:79]
    s_add_u32 s88, s88, 8192
    buffer_load_dwordx4 v[144:147], v1, s[40:43], s88 offen offset:0 sc1
    v_mfma_f32_16x16x32_bf16 v[80:83], a[180:183], v[96:99], v[80:83]
    v_mfma_f32_16x16x32_bf16 v[84:87], a[184:187], v[96:99], v[84:87]
    v_mfma_f32_16x16x32_bf16 v[88:91], a[188:191], v[96:99], v[88:91]
    v_mfma_f32_16x16x32_bf16 v[92:95], a[192:195], v[96:99], v[92:95]
    s_waitcnt vmcnt(11)
    v_mfma_f32_16x16x32_bf16 v[76:79], a[196:199], v[100:103], v[76:79]
    buffer_load_dwordx4 v[148:151], v1, s[40:43], s88 offen offset:1024 sc1
    v_mfma_f32_16x16x32_bf16 v[80:83], a[200:203], v[100:103], v[80:83]
    v_mfma_f32_16x16x32_bf16 v[84:87], a[204:207], v[100:103], v[84:87]
    v_mfma_f32_16x16x32_bf16 v[88:91], a[208:211], v[100:103], v[88:91]
    v_mfma_f32_16x16x32_bf16 v[92:95], a[212:215], v[100:103], v[92:95]
    s_waitcnt vmcnt(11)
    v_mfma_f32_16x16x32_bf16 v[76:79], a[216:219], v[104:107], v[76:79]
    buffer_load_dwordx4 v[152:155], v1, s[40:43], s88 offen offset:2048 sc1
    v_mfma_f32_16x16x32_bf16 v[80:83], a[220:223], v[104:107], v[80:83]
    v_mfma_f32_16x16x32_bf16 v[84:87], a[224:227], v[104:107], v[84:87]
    v_mfma_f32_16x16x32_bf16 v[88:91], a[228:231], v[104:107], v[88:91]
    v_mfma_f32_16x16x32_bf16 v[92:95], a[232:235], v[104:107], v[92:95]
    s_waitcnt vmcnt(11)
    v_mfma_f32_16x16x32_bf16 v[76:79], a[236:239], v[108:111], v[76:79]
    buffer_load_dwordx4 v[156:159], v1, s[40:43], s88 offen offset:3072 sc1
    v_mfma_f32_16x16x32_bf16 v[80:83], a[240:243], v[108:111], v[80:83]
    v_mfma_f32_16x16x32_bf16 v[84:87], a[244:247], v[108:111], v[84:87]
    v_mfma_f32_16x16x32_bf16 v[88:91], a[248:251], v[108:111], v[88:91]
    v_mfma_f32_16x16x32_bf16 v[92:95], a[252:255], v[108:111], v[92:95]
    s_waitcnt vmcnt(11)
    v_mfma_f32_16x16x32_bf16 v[16:19], a[16:19], v[112:115], 0
    v_mfma_f32_16x16x32_bf16 v[20:23], a[20:23], v[112:115], 0
    v_mfma_f32_16x16x32_bf16 v[24:27], a[24:27], v[112:115], 0
    v_mfma_f32_16x16x32_bf16 v[28:31], a[28:31], v[112:115], 0
    v_mfma_f32_16x16x32_bf16 v[32:35], a[32:35], v[112:115], 0
    s_waitcnt vmcnt(10)
    v_mfma_f32_16x16x32_bf16 v[16:19], a[36:39], v[116:119], v[16:19]
    v_mfma_f32_16x16x32_bf16 v[20:23], a[40:43], v[116:119], v[20:23]
    ds_write_b128 v11, v[76:79] offset:0
    v_mfma_f32_16x16x32_bf16 v[24:27], a[44:47], v[116:119], v[24:27]
    v_mfma_f32_16x16x32_bf16 v[28:31], a[48:51], v[116:119], v[28:31]
    ds_write_b128 v11, v[80:83] offset:1024
    v_mfma_f32_16x16x32_bf16 v[32:35], a[52:55], v[116:119], v[32:35]
    s_waitcnt vmcnt(9)
    v_mfma_f32_16x16x32_bf16 v[16:19], a[56:59], v[120:123], v[16:19]
    v_mfma_f32_16x16x32_bf16 v[20:23], a[60:63], v[120:123], v[20:23]
    ds_write_b128 v11, v[84:87] offset:2048
    v_mfma_f32_16x16x32_bf16 v[24:27], a[64:67], v[120:123], v[24:27]
    v_mfma_f32_16x16x32_bf16 v[28:31], a[68:71], v[120:123], v[28:31]
    ds_write_b128 v11, v[88:91] offset:3072
    v_mfma_f32_16x16x32_bf16 v[32:35], a[72:75], v[120:123], v[32:35]
    s_waitcnt vmcnt(8)
    v_mfma_f32_16x16x32_bf16 v[16:19], a[76:79], v[124:127], v[16:19]
    v_mfma_f32_16x16x32_bf16 v[20:23], a[80:83], v[124:127], v[20:23]
    ds_write_b128 v11, v[92:95] offset:4096
    v_mfma_f32_16x16x32_bf16 v[24:27], a[84:87], v[124:127], v[24:27]
    v_mfma_f32_16x16x32_bf16 v[28:31], a[88:91], v[124:127], v[28:31]
    v_mfma_f32_16x16x32_bf16 v[32:35], a[92:95], v[124:127], v[32:35]
    s_waitcnt vmcnt(7)
    v_mfma_f32_16x16x32_bf16 v[16:19], a[96:99], v[128:131], v[16:19]
    v_mfma_f32_16x16x32_bf16 v[20:23], a[100:103], v[128:131], v[20:23]
    v_mfma_f32_16x16x32_bf16 v[24:27], a[104:107], v[128:131], v[24:27]
    v_mfma_f32_16x16x32_bf16 v[28:31], a[108:111], v[128:131], v[28:31]
    v_mfma_f32_16x16x32_bf16 v[32:35], a[112:115], v[128:131], v[32:35]
    s_waitcnt vmcnt(6)
    v_mfma_f32_16x16x32_bf16 v[16:19], a[116:119], v[132:135], v[16:19]
    v_mfma_f32_16x16x32_bf16 v[20:23], a[120:123], v[132:135], v[20:23]
    v_mfma_f32_16x16x32_bf16 v[24:27], a[124:127], v[132:135], v[24:27]
    v_mfma_f32_16x16x32_bf16 v[28:31], a[128:131], v[132:135], v[28:31]
    v_mfma_f32_16x16x32_bf16 v[32:35], a[132:135], v[132:135], v[32:35]
    s_waitcnt vmcnt(5)
    v_mfma_f32_16x16x32_bf16 v[16:19], a[136:139], v[136:139], v[16:19]
    v_mfma_f32_16x16x32_bf16 v[20:23], a[140:143], v[136:139], v[20:23]
    v_mfma_f32_16x16x32_bf16 v[24:27], a[144:147], v[136:139], v[24:27]
    v_mfma_f32_16x16x32_bf16 v[28:31], a[148:151], v[136:139], v[28:31]
    v_mfma_f32_16x16x32_bf16 v[32:35], a[152:155], v[136:139], v[32:35]
    s_waitcnt vmcnt(4)
    v_mfma_f32_16x16x32_bf16 v[16:19], a[156:159], v[140:143], v[16:19]
    v_mfma_f32_16x16x32_bf16 v[20:23], a[160:163], v[140:143], v[20:23]
    v_mfma_f32_16x16x32_bf16 v[24:27], a[164:167], v[140:143], v[24:27]
    v_mfma_f32_16x16x32_bf16 v[28:31], a[168:171], v[140:143], v[28:31]
    v_mfma_f32_16x16x32_bf16 v[32:35], a[172:175], v[140:143], v[32:35]
    s_waitcnt vmcnt(3)
    v_mfma_f32_16x16x32_bf16 v[16:19], a[176:179], v[144:147], v[16:19]
    v_mfma_f32_16x16x32_bf16 v[20:23], a[180:183], v[144:147], v[20:23]
    v_mfma_f32_16x16x32_bf16 v[24:27], a[184:187], v[144:147], v[24:27]
    v_mfma_f32_16x16x32_bf16 v[28:31], a[188:191], v[144:147], v[28:31]
    v_mfma_f32_16x16x32_bf16 v[32:35], a[192:195], v[144:147], v[32:35]
    s_waitcnt vmcnt(2)
    v_mfma_f32_16x16x32_bf16 v[16:19], a[196:199], v[148:151], v[16:19]
    v_mfma_f32_16x16x32_bf16 v[20:23], a[200:203], v[148:151], v[20:23]
    v_mfma_f32_16x16x32_bf16 v[24:27], a[204:207], v[148:151], v[24:27]
    v_mfma_f32_16x16x32_bf16 v[28:31], a[208:211], v[148:151], v[28:31]
    v_mfma_f32_16x16x32_bf16 v[32:35], a[212:215], v[148:151], v[32:35]
    s_waitcnt vmcnt(1)
    v_mfma_f32_16x16x32_bf16 v[16:19], a[216:219], v[152:155], v[16:19]
    v_mfma_f32_16x16x32_bf16 v[20:23], a[220:223], v[152:155], v[20:23]
    v_mfma_f32_16x16x32_bf16 v[24:27], a[224:227], v[152:155], v[24:27]
    v_mfma_f32_16x16x32_bf16 v[28:31], a[228:231], v[152:155], v[28:31]
    v_mfma_f32_16x16x32_bf16 v[32:35], a[232:235], v[152:155], v[32:35]
    s_waitcnt lgkmcnt(0)
    s_barrier
    s_waitcnt vmcnt(0)
    v_mfma_f32_16x16x32_bf16 v[16:19], a[236:239], v[156:159], v[16:19]
    v_mfma_f32_16x16x32_bf16 v[20:23], a[240:243], v[156:159], v[20:23]
    ds_read_b128 v[36:39], v12 offset:0
    v_mfma_f32_16x16x32_bf16 v[24:27], a[244:247], v[156:159], v[24:27]
    ds_read_b128 v[40:43], v12 offset:1024
    v_mfma_f32_16x16x32_bf16 v[28:31], a[248:251], v[156:159], v[28:31]
    ds_read_b128 v[44:47], v12 offset:2048
    v_mfma_f32_16x16x32_bf16 v[32:35], a[252:255], v[156:159], v[32:35]
    ds_read_b128 v[48:51], v12 offset:3072
    ds_read_b128 v[52:55], v12 offset:4096
    ds_read_b128 v[56:59], v12 offset:5120
    ds_read_b128 v[60:63], v12 offset:6144
    ds_read_b128 v[64:67], v12 offset:7168
    ds_read_b128 v[68:71], v12 offset:8192
    ds_read_b128 v[72:75], v12 offset:9216
    ds_read_b128 v[76:79], v12 offset:10240
    ds_read_b128 v[80:83], v12 offset:11264
    ds_read_b128 v[84:87], v12 offset:12288
    ds_read_b128 v[88:91], v12 offset:13312
    ds_read_b128 v[92:95], v12 offset:14336
    s_waitcnt lgkmcnt(5)
    v_pk_add_f32 v[36:37], v[36:37], v[56:57]
    v_pk_add_f32 v[38:39], v[38:39], v[58:59]
    v_pk_add_f32 v[40:41], v[40:41], v[60:61]
    v_pk_add_f32 v[42:43], v[42:43], v[62:63]
    v_pk_add_f32 v[44:45], v[44:45], v[64:65]
    v_pk_add_f32 v[46:47], v[46:47], v[66:67]
    v_pk_add_f32 v[48:49], v[48:49], v[68:69]
    v_pk_add_f32 v[50:51], v[50:51], v[70:71]
    v_pk_add_f32 v[52:53], v[52:53], v[72:73]
    v_pk_add_f32 v[54:55], v[54:55], v[74:75]
    s_waitcnt lgkmcnt(0)
    v_pk_add_f32 v[16:17], v[16:17], v[76:77]
    v_pk_add_f32 v[18:19], v[18:19], v[78:79]
    v_pk_add_f32 v[20:21], v[20:21], v[80:81]
    v_pk_add_f32 v[22:23], v[22:23], v[82:83]
    v_pk_add_f32 v[24:25], v[24:25], v[84:85]
    v_pk_add_f32 v[26:27], v[26:27], v[86:87]
    v_pk_add_f32 v[28:29], v[28:29], v[88:89]
    v_pk_add_f32 v[30:31], v[30:31], v[90:91]
    v_pk_add_f32 v[32:33], v[32:33], v[92:93]
    v_pk_add_f32 v[34:35], v[34:35], v[94:95]
    v_pk_add_f32 v[16:17], v[16:17], v[36:37]
    v_pk_add_f32 v[18:19], v[18:19], v[38:39]
    v_pk_add_f32 v[20:21], v[20:21], v[40:41]
    v_pk_add_f32 v[22:23], v[22:23], v[42:43]
    v_pk_add_f32 v[24:25], v[24:25], v[44:45]
    v_pk_add_f32 v[26:27], v[26:27], v[46:47]
    v_pk_add_f32 v[28:29], v[28:29], v[48:49]
    v_pk_add_f32 v[30:31], v[30:31], v[50:51]
    v_pk_add_f32 v[32:33], v[32:33], v[52:53]
    v_pk_add_f32 v[34:35], v[34:35], v[54:55]
    v_pk_fma_f32 v[180:181], v[16:17], v[160:161], v[180:181]
    v_pk_fma_f32 v[182:183], v[18:19], v[162:163], v[182:183]
    v_pk_fma_f32 v[184:185], v[20:21], v[164:165], v[184:185]
    v_pk_fma_f32 v[186:187], v[22:23], v[166:167], v[186:187]
    v_pk_fma_f32 v[188:189], v[24:25], v[168:169], v[188:189]
    v_pk_fma_f32 v[190:191], v[26:27], v[170:171], v[190:191]
    v_pk_fma_f32 v[192:193], v[28:29], v[172:173], v[192:193]
    v_pk_fma_f32 v[194:195], v[30:31], v[174:175], v[194:195]
    v_pk_fma_f32 v[196:197], v[32:33], v[176:177], v[196:197]
    v_pk_fma_f32 v[198:199], v[34:35], v[178:179], v[198:199]
    v_cvt_pk_bf16_f32 v200, v180, v181
    v_cvt_pk_bf16_f32 v201, v182, v183
    v_cvt_pk_bf16_f32 v202, v184, v185
    v_cvt_pk_bf16_f32 v203, v186, v187
    v_cvt_pk_bf16_f32 v204, v188, v189
    v_cvt_pk_bf16_f32 v205, v190, v191
    v_cvt_pk_bf16_f32 v206, v192, v193
    v_cvt_pk_bf16_f32 v207, v194, v195
    v_cvt_pk_bf16_f32 v208, v196, v197
    v_cvt_pk_bf16_f32 v209, v198, v199
    v_mov_b32 v210, v208
    v_mov_b32 v211, v209
    v_permlane16_swap_b32 v200, v202
    v_permlane16_swap_b32 v201, v203
    v_permlane16_swap_b32 v204, v206
    v_permlane16_swap_b32 v205, v207
    v_permlane16_swap_b32 v208, v210
    v_permlane16_swap_b32 v209, v211
    buffer_store_dwordx4 v[200:203], v6, s[44:47], s84 offen offset:0
    buffer_store_dwordx4 v[204:207], v6, s[44:47], s84 offen offset:64
    s_mov_b32 exec_lo, 0xffff
    s_mov_b32 exec_hi, 0xffff
    buffer_store_dwordx4 v[208:211], v6, s[44:47], s84 offen offset:128
    s_mov_b64 exec, -1
    s_or_b32 s86, s2, s3
    s_cmp_lg_u32 s86, 0
    s_cbranch_scc1 ep_38
    v_mov_b32 v14, s6
    s_mov_b32 exec_lo, 1
    s_mov_b32 exec_hi, 0
    buffer_store_dword v14, off, s[40:43], 0 sc1
    s_mov_b64 exec, -1
ep_38:
L_end:
    s_endpgm
mcold_10:
    s_add_u32 s97, s97, 1
    s_sub_u32 s94, s94, 1
    s_cmp_eq_u32 s94, 0
    s_cbranch_scc1 mok_11
    s_mov_b32 s86, 0x24000
    buffer_load_dwordx4 v[52:55], v7, s[40:43], s86 offen sc1
    s_mov_b32 s86, 0x27c00
    buffer_load_dwordx4 v[56:59], v7, s[40:43], s86 offen sc1
    s_mov_b32 s86, 0x2b800
    buffer_load_dwordx4 v[60:63], v7, s[40:43], s86 offen sc1
    s_mov_b32 s86, 0x2f400
    buffer_load_dwordx4 v[64:67], v7, s[40:43], s86 offen sc1
    s_mov_b32 s86, 0x33000
    buffer_load_dwordx4 v[68:71], v7, s[40:43], s86 offen sc1
    s_mov_b32 s86, 0x24a00
    buffer_load_dwordx4 v[72:75], v7, s[40:43], s86 offen sc1
    s_mov_b32 s86, 0x28600
    buffer_load_dwordx4 v[76:79], v7, s[40:43], s86 offen sc1
    s_mov_b32 s86, 0x2c200
    buffer_load_dwordx4 v[80:83], v7, s[40:43], s86 offen sc1
    s_mov_b32 s86, 0x2fe00
    buffer_load_dwordx4 v[84:87], v7, s[40:43], s86 offen sc1
    s_mov_b32 s86, 0x33a00
    buffer_load_dwordx4 v[88:91], v7, s[40:43], s86 offen sc1
    s_waitcnt vmcnt(0)
    s_branch mchk_9
mcold_20:
    s_add_u32 s97, s97, 1
    s_sub_u32 s94, s94, 1
    s_cmp_eq_u32 s94, 0
    s_cbranch_scc1 mok_21
    s_mov_b32 s86, 0x24000
    buffer_load_dwordx4 v[52:55], v7, s[40:43], s86 offen sc1
    s_mov_b32 s86, 0x27c00
    buffer_load_dwordx4 v[56:59], v7, s[40:43], s86 offen sc1
    s_mov_b32 s86, 0x2b800
    buffer_load_dwordx4 v[60:63], v7, s[40:43], s86 offen sc1
    s_mov_b32 s86, 0x2f400
    buffer_load_dwordx4 v[64:67], v7, s[40:43], s86 offen sc1
    s_mov_b32 s86, 0x33000
    buffer_load_dwordx4 v[68:71], v7, s[40:43], s86 offen sc1
    s_mov_b32 s86, 0x24a00
    buffer_load_dwordx4 v[72:75], v7, s[40:43], s86 offen sc1
    s_mov_b32 s86, 0x28600
    buffer_load_dwordx4 v[76:79], v7, s[40:43], s86 offen sc1
    s_mov_b32 s86, 0x2c200
    buffer_load_dwordx4 v[80:83], v7, s[40:43], s86 offen sc1
    s_mov_b32 s86, 0x2fe00
    buffer_load_dwordx4 v[84:87], v7, s[40:43], s86 offen sc1
    s_mov_b32 s86, 0x33a00
    buffer_load_dwordx4 v[88:91], v7, s[40:43], s86 offen sc1
    s_waitcnt vmcnt(0)
    s_branch mchk_19
jcold_24:
    s_add_u32 s97, s97, 0x10000
    s_sub_u32 s94, s94, 1
    s_cmp_eq_u32 s94, 0
    s_cbranch_scc1 jok_25
    buffer_load_dwordx4 v[252:255], v13, s[40:43], 0 offen sc1
    s_waitcnt vmcnt(0)
    s_branch jchk_23
mcold_28:
    s_add_u32 s97, s97, 1
    s_sub_u32 s94, s94, 1
    s_cmp_eq_u32 s94, 0
    s_cbranch_scc1 mok_29
    s_mov_b32 s86, 0x25400
    buffer_load_dwordx4 v[220:223], v7, s[40:43], s86 offen sc1
    s_mov_b32 s86, 0x29000
    buffer_load_dwordx4 v[224:227], v7, s[40:43], s86 offen sc1
    s_mov_b32 s86, 0x25e00
    buffer_load_dwordx4 v[228:231], v7, s[40:43], s86 offen sc1
    s_mov_b32 s86, 0x29a00
    buffer_load_dwordx4 v[232:235], v7, s[40:43], s86 offen sc1
    s_mov_b32 s86, 0x26800
    buffer_load_dwordx4 v[236:239], v7, s[40:43], s86 offen sc1
    s_mov_b32 s86, 0x2a400
    buffer_load_dwordx4 v[240:243], v7, s[40:43], s86 offen sc1
    s_mov_b32 s86, 0x27200
    buffer_load_dwordx4 v[244:247], v7, s[40:43], s86 offen sc1
    s_mov_b32 s86, 0x2ae00
    buffer_load_dwordx4 v[248:251], v7, s[40:43], s86 offen sc1
    s_waitcnt vmcnt(0)
    s_branch mchk_27
CODE_END:
    s_endpgm
.section .rodata,"a"
.p2align 6
.amdhsa_kernel adaLN_cond__sliding_local_dilated__dense_activation_silu__prompt_kernel
  .amdhsa_next_free_vgpr 512
  .amdhsa_next_free_sgpr 102
  .amdhsa_accum_offset 256
  .amdhsa_group_segment_fixed_size 0
  .amdhsa_kernarg_size 88
  .amdhsa_user_sgpr_count 2
  .amdhsa_user_sgpr_kernarg_segment_ptr 1
  .amdhsa_system_sgpr_workgroup_id_x 1
.end_amdhsa_kernel
```
